```python
import torch

def _softmax(x, axis=-1):
    return torch.softmax(x, dim=axis)

def _gelu(x):
    return torch.nn.functional.gelu(x, approximate='tanh')

def _silu(x):
    return torch.nn.functional.silu(x)

def _sigmoid(x):
    return torch.sigmoid(x)

def _layernorm(x, axis=-1, eps=1e-05):
    m = x.mean(dim=axis, keepdim=True)
    v = x.var(dim=axis, keepdim=True, unbiased=False)
    return (x - m) / torch.sqrt(v + eps)

def _scatter_add(tgt, idx, src, axis=0):
    return tgt.clone().index_add_(axis, idx, src)

def _segment_sum(src, seg, n):
    out = torch.zeros((n,) + src.shape[1:], dtype=src.dtype)
    return out.index_add_(0, seg, src)

def _pad(x, pw):
    flat = tuple((v for pair in reversed(pw) for v in pair))
    return torch.nn.functional.pad(x, flat)
kernel_name = 'gather_scatter__molecular_angular_painn__graph'

def setup_inputs():

    _w = lambda a: (lambda t: t.to(torch.bfloat16) if t.is_floating_point() else t)(torch.as_tensor(a))
    N, deg, D = (10000, 64, 64)
    n_rbf = max(16, 4)
    E = N * deg
    cutoff = 5.0
    freqs = (torch.arange(1, n_rbf + 1) * torch.pi / cutoff).to(float)
    return {'sv': _w((lambda *s: torch.randn(*s, dtype=torch.bfloat16) * 0.4)(N, 4, D) * 0.3), 'pos': _w((lambda *s: torch.randn(*s, dtype=torch.bfloat16) * 1.6)(N, 3) * 1.2), 'src': _w((lambda lo, hi, *s: torch.randint(lo, hi, s))(0, N, E).to(torch.int64)), 'dst': _w((lambda lo, hi, *s: torch.randint(lo, hi, s))(0, N, E).to(torch.int64)), 'freqs': _w(freqs), 'w_phi1': _w((lambda *s: torch.randn(*s, dtype=torch.bfloat16) * 3.2)(D, D) / D ** 0.5), 'w_phi2': _w((lambda *s: torch.randn(*s, dtype=torch.bfloat16) * 1.6)(D, 3 * D) / D ** 0.5), 'w_rbf': _w((lambda *s: torch.randn(*s, dtype=torch.bfloat16) * 1.6)(n_rbf, 3 * D) / n_rbf ** 0.5)}

def reference(sv, pos, src, dst, freqs, w_phi1, w_phi2, w_rbf):
    N, _, D = sv.shape
    E = src.shape[0]
    PI, cutoff = (3.141592653589793, 5.0)
    s, v = (sv[:, 0, :].clone(), sv[:, 1:, :].clone())
    r_vec = pos[src] - pos[dst]
    d = torch.sqrt((r_vec * r_vec).sum(-1) + 1e-08)
    r_hat = r_vec / d[:, None]
    rbf = torch.sin(d[:, None] * freqs[None, :]) / d[:, None]
    fcut = 0.5 * (torch.cos(PI * d / cutoff) + 1.0)
    fcut = torch.where(d < cutoff, fcut, 0.0 * d)
    Wf = rbf @ w_rbf * fcut[:, None]
    phi = (_silu(s @ w_phi1) @ w_phi2)[src]
    m = phi * Wf
    m_s, m_vv, m_vr = (m[:, :D].clone(), m[:, D:2 * D].clone(), m[:, 2 * D:].clone())
    ds = _segment_sum(m_s, dst, N)
    dv_e = m_vv[:, None, :] * v[src] + m_vr[:, None, :] * r_hat[:, :, None]
    dv = _segment_sum(dv_e.reshape(E, 3 * D), dst, N).reshape(N, 3, D)
    return sv + torch.concatenate([ds[:, None, :], dv], axis=1)
```

```asm
; @launch grid=(256,1,1) block=(1024,1,1) lds=163840
.amdgcn_target "amdgcn-amd-amdhsa--gfx950"
.text
.globl gather_scatter__molecular_angular_painn__graph_kernel
.p2align 8
.type gather_scatter__molecular_angular_painn__graph_kernel,@function
gather_scatter__molecular_angular_painn__graph_kernel:
    s_cmp_ge_u32 s2, 256
    s_cbranch_scc1 K_END
    s_load_dwordx16 s[68:83], s[0:1], 0
    s_load_dwordx2 s[34:35], s[0:1], 80
    s_load_dwordx4 s[84:87], s[0:1], 64
    s_memrealtime s[96:97]
    s_getpc_b64 s[36:37]
K1_PC:
    s_sub_u32 s36, s36, K1_PC-gather_scatter__molecular_angular_painn__graph_kernel
    s_subb_u32 s37, s37, 0
    s_mov_b32 s38, CODE_END-gather_scatter__molecular_angular_painn__graph_kernel
    s_mov_b32 s39, 0x20000
    v_lshlrev_b32 v127, 7, v0
    buffer_load_dword v127, v127, s[36:39], 0 offen
    v_lshrrev_b32 v2, 6, v0
    v_and_b32 v3, 63, v0
    v_readfirstlane_b32 s4, v2
    v_lshlrev_b32 v2, 4, v3
    v_lshlrev_b32 v1, 4, v0
    s_mul_i32 s90, s2, 10000
    s_lshr_b32 s91, s2, 3
    s_lshl_b32 s91, s91, 1
    s_lshl_b32 s92, s4, 2
    s_add_u32 s91, s91, s92
    s_add_u32 s92, s91, 0
    s_and_b32 s92, s92, 63
    s_min_u32 s92, s92, 58
    s_lshl_b32 s92, s92, 10
    s_add_u32 s93, s91, 1
    s_and_b32 s93, s93, 63
    s_min_u32 s93, s93, 58
    s_lshl_b32 s93, s93, 10
    s_add_u32 s94, s91, 2
    s_and_b32 s94, s94, 63
    s_min_u32 s94, s94, 58
    s_lshl_b32 s94, s94, 10
    s_add_u32 s95, s91, 3
    s_and_b32 s95, s95, 63
    s_min_u32 s95, s95, 58
    s_lshl_b32 s95, s95, 10
    s_mov_b32 s58, 60000
    s_mov_b32 s59, 0x20000
    s_mov_b32 s62, 10000
    s_mov_b32 s63, 0x20000
    s_mov_b32 s66, 10000
    s_mov_b32 s67, 0x20000
    v_and_b32 v29, 127, v0
    v_lshlrev_b32 v29, 2, v29
    v_mov_b32 v30, 0
    ds_write_b32 v29, v30 offset:2880
    s_add_u32 m0, s92, 86528
    s_waitcnt lgkmcnt(0)
    s_mov_b32 s56, s70
    s_mov_b32 s57, s71
    buffer_load_dwordx4 v2, s[56:59], s92 offen lds
    s_add_u32 s60, s72, s90
    s_addc_u32 s61, s73, 0
    s_add_u32 s64, s74, s90
    s_addc_u32 s65, s75, 0
    s_cmp_ge_u32 s4, 10
    s_cbranch_scc1 K1_NOE
    buffer_load_dwordx4 v[4:7], v1, s[60:63], 0 offen
    buffer_load_dwordx4 v[8:11], v1, s[64:67], 0 offen
K1_NOE:
    s_add_u32 m0, s93, 86528
    s_nop 0
    buffer_load_dwordx4 v2, s[56:59], s93 offen lds
    s_add_u32 m0, s94, 86528
    s_nop 0
    buffer_load_dwordx4 v2, s[56:59], s94 offen lds
    s_add_u32 m0, s95, 86528
    s_nop 0
    buffer_load_dwordx4 v2, s[56:59], s95 offen lds
    s_mov_b32 s98, s70
    s_mov_b32 s99, s71
    s_mov_b32 s64, s86
    s_mov_b32 s65, s87
    s_mov_b32 s66, 8
    s_mov_b32 s67, 0x20000
    s_lshl_b32 s90, s2, 4
    s_add_u32 s90, s90, s4
    s_cmp_lg_u32 s90, 4095
    s_cbranch_scc1 K1_NOPUB
    s_bitset1_b32 s97, 31
    v_mov_b32 v122, s96
    v_mov_b32 v123, s97
    buffer_store_dwordx2 v[122:123], v2, s[64:67], 0 offen sc1
K1_NOPUB:
    v_mov_b32 v125, 0
    s_cmp_ge_u32 s4, 10
    s_cbranch_scc1 K1_SIDE
    s_and_b32 s90, s2, 7
    s_lshr_b32 s3, s2, 3
    s_lshr_b32 s5, s90, 2
    s_and_b32 s90, s90, 3
    s_lshl_b32 s90, s90, 5
    s_add_u32 s3, s3, s90
    s_sub_u32 s7, 10127, s3
    s_lshr_b32 s7, s7, 7
    s_mov_b32 s8, 0
    s_movk_i32 s9, 192
    s_mov_b32 s10, 1
    s_mov_b32 s11, 1
    s_mov_b32 s13, 0x05040100
    s_mov_b32 s14, 0x07060302
    s_lshl_b32 s90, s3, 9
    s_sub_u32 s91, 5120000, s90
    s_add_u32 s40, s68, s90
    s_addc_u32 s41, s69, 0
    s_mov_b32 s42, s91
    s_mov_b32 s43, 0x20000
    s_add_u32 s44, s84, s90
    s_addc_u32 s45, s85, 0
    s_mov_b32 s46, s91
    s_mov_b32 s47, 0x20000
    s_mov_b32 s36, s34
    s_mov_b32 s37, s35
    s_mov_b32 s38, 6400000
    s_mov_b32 s39, 0x20000
    s_mov_b32 s48, s34
    s_mov_b32 s49, s35
    s_mov_b32 s50, 9581184
    s_mov_b32 s51, 0x20000
    s_mov_b32 s28, 1
    s_lshl_b32 s6, s4, 15
    s_lshl_b32 s90, s3, 4
    s_add_u32 s6, s6, s90
    s_add_u32 s6, s6, 6466176
    v_and_b32 v12, 15, v3
    v_lshrrev_b32 v13, 4, v3
    s_mov_b32 s52, s82
    s_mov_b32 s53, s83
    s_mov_b32 s54, 6144
    s_mov_b32 s55, 0x20000
    s_and_b32 s32, s4, 7
    s_lshr_b32 s91, s32, 1
    s_and_b32 s92, s32, 1
    s_lshl_b32 s93, s91, 6
    s_add_u32 s93, s93, 64
    s_lshl_b32 s94, s5, 5
    s_add_u32 s93, s93, s94
    s_sub_u32 s91, s91, 2
    s_lshl_b32 s91, s91, 5
    s_cmp_lt_u32 s32, 4
    s_cselect_b32 s91, s93, s91
    s_add_u32 s91, s91, s92
    s_lshl_b32 s33, s91, 1
    s_lshl_b32 s32, s32, 10
    v_mul_u32_u24 v78, 0x600, v13
    v_lshl_add_u32 v78, v12, 2, v78
    s_add_u32 s90, s4, 0
    s_mul_i32 s91, s90, 205
    s_lshr_b32 s91, s91, 11
    s_mul_i32 s92, s91, 10
    s_sub_u32 s92, s90, s92
    s_lshl_b32 s93, s92, 6
    v_add_u32 v110, s93, v3
    v_mul_u32_u24 v14, 1639, v110
    v_lshrrev_b32 v14, 16, v14
    v_add_u32 v110, v110, v14
    s_mul_i32 s93, s91, 10496
    s_add_u32 s93, s93, 35840
    v_lshl_add_u32 v110, v110, 4, s93
    s_lshl_b32 s91, s91, 8
    s_add_u32 s91, s91, s2
    s_mul_i32 s91, s91, 10240
    s_lshl_b32 s92, s92, 10
    s_add_u32 s30, s91, s92
    s_add_u32 s90, s4, 16
    s_mul_i32 s91, s90, 205
    s_lshr_b32 s91, s91, 11
    s_mul_i32 s92, s91, 10
    s_sub_u32 s92, s90, s92
    s_lshl_b32 s93, s92, 6
    v_add_u32 v111, s93, v3
    v_mul_u32_u24 v14, 1639, v111
    v_lshrrev_b32 v14, 16, v14
    v_add_u32 v111, v111, v14
    s_mul_i32 s93, s91, 10496
    s_add_u32 s93, s93, 35840
    v_lshl_add_u32 v111, v111, 4, s93
    s_lshl_b32 s91, s91, 8
    s_add_u32 s91, s91, s2
    s_mul_i32 s91, s91, 10240
    s_lshl_b32 s92, s92, 10
    s_add_u32 s31, s91, s92
    s_lshr_b32 s90, s4, 2
    s_and_b32 s91, s4, 3
    v_bfe_u32 v14, v3, 2, 2
    v_and_b32 v15, 3, v3
    v_lshrrev_b32 v26, 1, v14
    v_and_b32 v27, 1, v13
    v_lshl_or_b32 v27, v27, 1, v26
    v_xor_b32 v27, s91, v27
    v_lshlrev_b32 v27, 5, v27
    v_lshl_add_u32 v27, v15, 3, v27
    v_add_u32 v27, 35840, v27
    v_lshl_add_u32 v80, v13, 3, v14
    v_lshl_add_u32 v80, v80, 7, v27
    v_lshl_add_u32 v81, v13, 2, v14
    v_mul_u32_u24 v81, 0x180, v81
    v_add_u32 v81, v81, v27
    s_lshl_b32 s92, s90, 13
    s_add_u32 s92, s92, 138752
    s_cmp_eq_u32 s90, 0
    s_cselect_b32 s92, 68608, s92
    v_lshlrev_b32 v26, 9, v12
    v_add_u32 v26, s92, v26
    v_xor_b32 v112, v13, v12
    v_lshl_add_u32 v112, v112, 4, v26
    v_xor_b32 v113, 64, v112
    s_lshl_b32 s92, s91, 1
    v_lshrrev_b32 v114, 1, v13
    v_add_u32 v114, s92, v114
    v_xor_b32 v114, v114, v12
    v_lshl_add_u32 v114, v114, 4, v26
    v_and_b32 v27, 1, v13
    v_lshl_add_u32 v114, v27, 3, v114
    v_xor_b32 v115, 0x80, v114
    s_lshl_b32 s92, s90, 11
    s_add_u32 s92, s92, 76800
    v_lshlrev_b32 v82, 5, v3
    v_add_u32 v82, s92, v82
    s_lshl_b32 s92, s91, 3
    v_add_u32 v83, s92, v82
    s_mul_i32 s92, s90, 10496
    s_add_u32 s92, s92, 35840
    v_mul_u32_u24 v84, 656, v12
    v_add_u32 v84, s92, v84
    s_lshl_b32 s92, s91, 5
    v_lshl_add_u32 v79, v13, 3, v84
    v_add_u32 v79, s92, v79
    v_lshl_add_u32 v84, v13, 5, v84
    s_lshl_b32 s92, s91, 7
    v_add_u32 v84, s92, v84
    v_lshlrev_b32 v119, 5, v3
    v_and_b32 v12, 15, v3
    v_lshrrev_b32 v13, 4, v3
    v_lshlrev_b32 v89, 11, v12
    v_lshlrev_b32 v90, 2, v13
    s_lshl_b32 s90, s4, 4
    v_add_u32 v85, s90, v13
    s_mov_b32 s90, 10112
    v_mul_lo_u32 v85, v85, s90
    v_lshlrev_b32 v86, 2, v12
    v_add_u32 v86, s8, v86
    v_add_u32 v87, 64, v86
    v_add_u32 v88, 0x80, v86
    v_add_u32 v85, v85, v86
    s_add_u32 s25, s8, s9
    s_mov_b32 s29, 65536
    v_mov_b32 v91, 0
    v_mov_b32 v116, 0
    v_mov_b32 v117, 4
    v_mov_b32 v118, 0x40000000
    s_movk_i32 s68, 625
    v_cmp_gt_u32 s[80:81], s68, v0
    s_mov_b32 s68, 86528
    s_movk_i32 s70, 16541
    s_mov_b32 s69, 0xfe000000
    s_mov_b32 s73, 214749
    s_movk_i32 s74, 625
    s_mul_i32 s71, s2, 10112
    s_add_u32 s71, s71, 6992512
    s_lshl_b32 s72, s4, 9
    s_add_u32 s72, s72, 13632
    s_waitcnt vmcnt(3)
    v_lshlrev_b32 v28, 18, v8
    v_and_or_b32 v28, v28, s69, v4
    v_and_b32 v40, 127, v8
    v_lshlrev_b32 v40, 2, v40
    v_mad_u32_u24 v48, v4, 6, s68
    v_and_b32 v48, -4, v48
    v_lshlrev_b32 v4, 4, v4
    v_mad_u32_u24 v52, v8, 6, s68
    v_and_b32 v52, -4, v52
    v_lshlrev_b32 v8, 4, v8
    v_lshlrev_b32 v29, 18, v9
    v_and_or_b32 v29, v29, s69, v5
    v_and_b32 v41, 127, v9
    v_lshlrev_b32 v41, 2, v41
    v_mad_u32_u24 v49, v5, 6, s68
    v_and_b32 v49, -4, v49
    v_lshlrev_b32 v5, 4, v5
    v_mad_u32_u24 v53, v9, 6, s68
    v_and_b32 v53, -4, v53
    v_lshlrev_b32 v9, 4, v9
    v_lshlrev_b32 v30, 18, v10
    v_and_or_b32 v30, v30, s69, v6
    v_and_b32 v42, 127, v10
    v_lshlrev_b32 v42, 2, v42
    v_mad_u32_u24 v50, v6, 6, s68
    v_and_b32 v50, -4, v50
    v_lshlrev_b32 v6, 4, v6
    v_mad_u32_u24 v54, v10, 6, s68
    v_and_b32 v54, -4, v54
    v_lshlrev_b32 v10, 4, v10
    v_lshlrev_b32 v31, 18, v11
    v_and_or_b32 v31, v31, s69, v7
    v_and_b32 v43, 127, v11
    v_lshlrev_b32 v43, 2, v43
    v_mad_u32_u24 v51, v7, 6, s68
    v_and_b32 v51, -4, v51
    v_lshlrev_b32 v7, 4, v7
    v_mad_u32_u24 v55, v11, 6, s68
    v_and_b32 v55, -4, v55
    v_lshlrev_b32 v11, 4, v11
    s_waitcnt vmcnt(0) lgkmcnt(0)
    s_barrier
    ds_read2_b32 v[12:13], v48 offset0:0 offset1:1
    ds_read2_b32 v[20:21], v52 offset0:0 offset1:1
    ds_read2_b32 v[14:15], v49 offset0:0 offset1:1
    ds_read2_b32 v[22:23], v53 offset0:0 offset1:1
    ds_read2_b32 v[16:17], v50 offset0:0 offset1:1
    ds_read2_b32 v[24:25], v54 offset0:0 offset1:1
    ds_read2_b32 v[18:19], v51 offset0:0 offset1:1
    ds_read2_b32 v[26:27], v55 offset0:0 offset1:1
    s_waitcnt lgkmcnt(4)
    v_alignbit_b32 v49, v13, v12, v4
    v_lshrrev_b32 v52, v4, v13
    v_lshlrev_b32 v48, 16, v49
    v_and_b32 v49, 0xffff0000, v49
    v_lshlrev_b32 v52, 16, v52
    v_alignbit_b32 v57, v21, v20, v8
    v_lshrrev_b32 v58, v8, v21
    v_lshlrev_b32 v56, 16, v57
    v_and_b32 v57, 0xffff0000, v57
    v_lshlrev_b32 v58, 16, v58
    v_sub_f32 v48, v48, v56
    v_sub_f32 v49, v49, v57
    v_sub_f32 v52, v52, v58
    v_alignbit_b32 v51, v15, v14, v5
    v_lshrrev_b32 v53, v5, v15
    v_lshlrev_b32 v50, 16, v51
    v_and_b32 v51, 0xffff0000, v51
    v_lshlrev_b32 v53, 16, v53
    v_alignbit_b32 v57, v23, v22, v9
    v_lshrrev_b32 v58, v9, v23
    v_lshlrev_b32 v56, 16, v57
    v_and_b32 v57, 0xffff0000, v57
    v_lshlrev_b32 v58, 16, v58
    v_sub_f32 v50, v50, v56
    v_sub_f32 v51, v51, v57
    v_sub_f32 v53, v53, v58
    v_cvt_pk_bf16_f32 v54, v48, v49
    v_lshlrev_b32 v48, 16, v54
    v_and_b32 v49, 0xffff0000, v54
    v_pk_mul_f32 v[48:49], v[48:49], v[48:49]
    v_cvt_pk_bf16_f32 v54, v48, v49
    v_lshlrev_b32 v48, 16, v54
    v_and_b32 v49, 0xffff0000, v54
    v_cvt_pk_bf16_f32 v54, v50, v51
    v_lshlrev_b32 v50, 16, v54
    v_and_b32 v51, 0xffff0000, v54
    v_pk_mul_f32 v[50:51], v[50:51], v[50:51]
    v_cvt_pk_bf16_f32 v54, v50, v51
    v_lshlrev_b32 v50, 16, v54
    v_and_b32 v51, 0xffff0000, v54
    v_cvt_pk_bf16_f32 v54, v52, v53
    v_lshlrev_b32 v52, 16, v54
    v_and_b32 v53, 0xffff0000, v54
    v_pk_mul_f32 v[52:53], v[52:53], v[52:53]
    v_cvt_pk_bf16_f32 v54, v52, v53
    v_lshlrev_b32 v52, 16, v54
    v_and_b32 v53, 0xffff0000, v54
    v_add_f32 v48, v48, v49
    v_add_f32 v50, v50, v51
    v_add_f32 v52, v48, v52
    v_add_f32 v53, v50, v53
    v_cvt_pk_bf16_f32 v54, v52, v53
    v_lshlrev_b32 v52, 16, v54
    v_and_b32 v53, 0xffff0000, v54
    v_add_f32 v52, 0x322bcc77, v52
    v_add_f32 v53, 0x322bcc77, v53
    v_cvt_pk_bf16_f32 v54, v52, v53
    v_lshlrev_b32 v52, 16, v54
    v_and_b32 v53, 0xffff0000, v54
    v_sqrt_f32 v52, v52
    v_sqrt_f32 v53, v53
    s_waitcnt lgkmcnt(0)
    v_cvt_pk_bf16_f32 v54, v52, v53
    v_and_b32 v52, 0xffff, v54
    v_lshrrev_b32 v53, 16, v54
    v_cmp_gt_u32 s[82:83], s70, v52
    s_and_b64 s[82:83], s[82:83], s[80:81]
    s_mov_b64 exec, s[82:83]
    ds_add_rtn_u32 v44, v40, v117 offset:2880
    s_mov_b64 exec, -1
    v_max_u32 v52, 0x38d2, v52
    v_subrev_u32 v52, 0x38d1, v52
    v_lshl_or_b32 v28, v52, 14, v28
    v_cmp_gt_u32 s[84:85], s70, v53
    s_and_b64 s[84:85], s[84:85], s[80:81]
    s_mov_b64 exec, s[84:85]
    ds_add_rtn_u32 v45, v41, v117 offset:2880
    s_mov_b64 exec, -1
    v_max_u32 v53, 0x38d2, v53
    v_subrev_u32 v53, 0x38d1, v53
    v_lshl_or_b32 v29, v53, 14, v29
    v_alignbit_b32 v49, v17, v16, v6
    v_lshrrev_b32 v52, v6, v17
    v_lshlrev_b32 v48, 16, v49
    v_and_b32 v49, 0xffff0000, v49
    v_lshlrev_b32 v52, 16, v52
    v_alignbit_b32 v57, v25, v24, v10
    v_lshrrev_b32 v58, v10, v25
    v_lshlrev_b32 v56, 16, v57
    v_and_b32 v57, 0xffff0000, v57
    v_lshlrev_b32 v58, 16, v58
    v_sub_f32 v48, v48, v56
    v_sub_f32 v49, v49, v57
    v_sub_f32 v52, v52, v58
    v_alignbit_b32 v51, v19, v18, v7
    v_lshrrev_b32 v53, v7, v19
    v_lshlrev_b32 v50, 16, v51
    v_and_b32 v51, 0xffff0000, v51
    v_lshlrev_b32 v53, 16, v53
    v_alignbit_b32 v57, v27, v26, v11
    v_lshrrev_b32 v58, v11, v27
    v_lshlrev_b32 v56, 16, v57
    v_and_b32 v57, 0xffff0000, v57
    v_lshlrev_b32 v58, 16, v58
    v_sub_f32 v50, v50, v56
    v_sub_f32 v51, v51, v57
    v_sub_f32 v53, v53, v58
    v_cvt_pk_bf16_f32 v54, v48, v49
    v_lshlrev_b32 v48, 16, v54
    v_and_b32 v49, 0xffff0000, v54
    v_pk_mul_f32 v[48:49], v[48:49], v[48:49]
    v_cvt_pk_bf16_f32 v54, v48, v49
    v_lshlrev_b32 v48, 16, v54
    v_and_b32 v49, 0xffff0000, v54
    v_cvt_pk_bf16_f32 v54, v50, v51
    v_lshlrev_b32 v50, 16, v54
    v_and_b32 v51, 0xffff0000, v54
    v_pk_mul_f32 v[50:51], v[50:51], v[50:51]
    v_cvt_pk_bf16_f32 v54, v50, v51
    v_lshlrev_b32 v50, 16, v54
    v_and_b32 v51, 0xffff0000, v54
    v_cvt_pk_bf16_f32 v54, v52, v53
    v_lshlrev_b32 v52, 16, v54
    v_and_b32 v53, 0xffff0000, v54
    v_pk_mul_f32 v[52:53], v[52:53], v[52:53]
    v_cvt_pk_bf16_f32 v54, v52, v53
    v_lshlrev_b32 v52, 16, v54
    v_and_b32 v53, 0xffff0000, v54
    v_add_f32 v48, v48, v49
    v_add_f32 v50, v50, v51
    v_add_f32 v52, v48, v52
    v_add_f32 v53, v50, v53
    v_cvt_pk_bf16_f32 v54, v52, v53
    v_lshlrev_b32 v52, 16, v54
    v_and_b32 v53, 0xffff0000, v54
    v_add_f32 v52, 0x322bcc77, v52
    v_add_f32 v53, 0x322bcc77, v53
    v_cvt_pk_bf16_f32 v54, v52, v53
    v_lshlrev_b32 v52, 16, v54
    v_and_b32 v53, 0xffff0000, v54
    v_sqrt_f32 v52, v52
    v_sqrt_f32 v53, v53
    s_nop 0
    v_cvt_pk_bf16_f32 v54, v52, v53
    v_and_b32 v52, 0xffff, v54
    v_lshrrev_b32 v53, 16, v54
    v_cmp_gt_u32 s[86:87], s70, v52
    s_and_b64 s[86:87], s[86:87], s[80:81]
    s_mov_b64 exec, s[86:87]
    ds_add_rtn_u32 v46, v42, v117 offset:2880
    s_mov_b64 exec, -1
    v_max_u32 v52, 0x38d2, v52
    v_subrev_u32 v52, 0x38d1, v52
    v_lshl_or_b32 v30, v52, 14, v30
    v_cmp_gt_u32 s[88:89], s70, v53
    s_and_b64 s[88:89], s[88:89], s[80:81]
    s_mov_b64 exec, s[88:89]
    ds_add_rtn_u32 v47, v43, v117 offset:2880
    s_mov_b64 exec, -1
    v_max_u32 v53, 0x38d2, v53
    v_subrev_u32 v53, 0x38d1, v53
    v_lshl_or_b32 v31, v53, 14, v31
    v_lshlrev_b32 v55, 3, v3
    v_add_u32 v54, s72, v55
    s_waitcnt lgkmcnt(0)
    s_barrier
    ds_read_b64 v[56:57], v55 offset:2880
    buffer_load_ushort v92, v78, s[52:55], s33 offen offset:0
    buffer_load_ushort v93, v78, s[52:55], s33 offen offset:384
    buffer_load_ushort v94, v78, s[52:55], s33 offen offset:768
    buffer_load_ushort v95, v78, s[52:55], s33 offen offset:1152
    v_add_u32 v40, s72, v40
    v_add_u32 v41, s72, v41
    v_add_u32 v42, s72, v42
    v_add_u32 v43, s72, v43
    s_waitcnt lgkmcnt(0)
    v_add_u32 v58, v56, v57
    v_mov_b32 v59, v58
    s_nop 1
    v_add_u32_dpp v59, v59, v59 row_shr:1 row_mask:0xf bank_mask:0xf bound_ctrl:0
    s_nop 1
    v_add_u32_dpp v59, v59, v59 row_shr:2 row_mask:0xf bank_mask:0xf bound_ctrl:0
    s_nop 1
    v_add_u32_dpp v59, v59, v59 row_shr:4 row_mask:0xf bank_mask:0xf bound_ctrl:0
    s_nop 1
    v_add_u32_dpp v59, v59, v59 row_shr:8 row_mask:0xf bank_mask:0xf bound_ctrl:0
    s_nop 1
    v_add_u32_dpp v59, v59, v59 row_bcast:15 row_mask:0xa bank_mask:0xf
    s_nop 1
    v_add_u32_dpp v59, v59, v59 row_bcast:31 row_mask:0xc bank_mask:0xf
    v_sub_u32 v60, v59, v58
    v_add_u32 v61, v60, v56
    ds_write_b64 v54, v[60:61]
    ds_read_b32 v48, v40
    ds_read_b32 v49, v41
    ds_read_b32 v50, v42
    ds_read_b32 v51, v43
    v_readlane_b32 s73, v59, 63
    v_lshl_or_b32 v120, v56, 16, v60
    v_lshl_or_b32 v124, v57, 16, v61
    v_cmp_gt_u32 s[74:75], s73, v1
    s_waitcnt lgkmcnt(0)
    v_add_u32 v48, v48, v44
    s_mov_b64 exec, s[82:83]
    ds_write_b32 v48, v28 offset:3392
    s_mov_b64 exec, -1
    v_add_u32 v49, v49, v45
    s_mov_b64 exec, s[84:85]
    ds_write_b32 v49, v29 offset:3392
    s_mov_b64 exec, -1
    v_add_u32 v50, v50, v46
    s_mov_b64 exec, s[86:87]
    ds_write_b32 v50, v30 offset:3392
    s_mov_b64 exec, -1
    v_add_u32 v51, v51, v47
    s_mov_b64 exec, s[88:89]
    ds_write_b32 v51, v31 offset:3392
    s_mov_b64 exec, -1
    s_waitcnt lgkmcnt(0)
    s_barrier
    s_mov_b64 exec, s[74:75]
    s_cbranch_execz K1_SD
    ds_read_b128 v[4:7], v1 offset:3392
    s_waitcnt lgkmcnt(0)
    buffer_store_dwordx4 v[4:7], v1, s[48:51], s71 offen sc1
K1_SD:
    s_mov_b64 exec, -1
    s_branch K1_JOIN
K1_SIDE:
    s_mov_b32 s16, s68
    s_mov_b32 s17, s69
    s_mov_b32 s18, 5120000
    s_mov_b32 s19, 0x20000
    s_mov_b32 s56, s78
    s_mov_b32 s57, s79
    s_mov_b32 s58, 8192
    s_mov_b32 s59, 0x20000
    s_mov_b32 s60, s80
    s_mov_b32 s61, s81
    s_mov_b32 s62, 24576
    s_mov_b32 s63, 0x20000
    s_mov_b32 s52, s82
    s_mov_b32 s53, s83
    s_mov_b32 s54, 6144
    s_mov_b32 s55, 0x20000
    s_sub_u32 s26, s4, 10
    s_lshr_b32 s27, s26, 1
    s_lshl_b32 s29, s27, 8
    s_add_u32 s29, s29, s2
    s_lshl_b32 s29, s29, 13
    s_and_b32 s27, s26, 1
    s_lshl_b32 s15, s27, 12
    s_add_u32 s29, s29, s15
    s_lshl_b32 s27, s27, 3
    v_lshrrev_b32 v10, 5, v3
    v_add_u32 v10, s27, v10
    v_lshlrev_b32 v10, 4, v10
    v_xor_b32 v68, v2, v10
    v_xor_b32 v69, 32, v68
    v_xor_b32 v70, 64, v68
    v_xor_b32 v71, 96, v68
    s_lshl_b32 s27, s26, 12
    s_add_u32 s15, s27, 138752
    s_add_u32 s27, s27, 68608
    s_cmp_lt_u32 s26, 2
    s_cselect_b32 m0, s27, s15
    s_lshr_b32 s27, s2, 3
    s_lshl_b32 s27, s27, 10
    v_add_u32 v11, s27, v2
    v_subrev_u32 v12, 0x2000, v11
    s_cmp_lg_u32 s4, 15
    s_cbranch_scc1 K1_NOWPF
    buffer_load_dword v67, v11, s[56:59], 0 offen
    buffer_load_dword v67, v12, s[60:63], 0 offen
    buffer_load_dword v67, v11, s[52:55], 0 offen
    s_waitcnt vmcnt(3)
    s_branch K1_WPFD
K1_NOWPF:
    s_mov_b32 s88, s76
    s_mov_b32 s89, s77
    s_mov_b32 s90, 32
    s_mov_b32 s91, 0x20000
    v_and_b32 v100, 7, v3
    v_lshlrev_b32 v100, 2, v100
    buffer_load_dword v101, v100, s[88:91], 0 offen
    s_waitcnt vmcnt(1)
K1_WPFD:
    s_waitcnt lgkmcnt(0)
    s_barrier
    buffer_load_dwordx4 v68, s[16:19], s29 offen offset:0 lds
    buffer_load_dwordx4 v69, s[16:19], s29 offen offset:1024 lds
    buffer_load_dwordx4 v70, s[16:19], s29 offen offset:2048 lds
    buffer_load_dwordx4 v71, s[16:19], s29 offen offset:3072 lds
K1_WLa:
    s_lshl_b32 s27, s26, 10
    s_add_u32 m0, s27, 35840
    s_cmp_ge_u32 s26, 8
    s_cbranch_scc1 K1_W2a
    s_and_b32 s15, s26, 1
    s_lshl_b32 s15, s15, 1
    v_bfe_u32 v10, v3, 4, 1
    v_or_b32 v10, s15, v10
    v_lshlrev_b32 v10, 5, v10
    v_xor_b32 v10, v2, v10
    buffer_load_dwordx4 v10, s[56:59], s27 offen lds
    s_branch K1_WGa
K1_W2a:
    s_sub_u32 s27, s27, 8192
    s_lshr_b32 s15, s27, 4
    v_add_u32 v10, s15, v3
    v_mul_u32_u24 v10, 1366, v10
    v_bfe_u32 v10, v10, 16, 2
    v_lshlrev_b32 v10, 5, v10
    v_xor_b32 v10, v2, v10
    buffer_load_dwordx4 v10, s[60:63], s27 offen lds
K1_WGa:
    s_add_u32 s26, s26, 6
    s_cmp_lt_u32 s26, 32
    s_cbranch_scc1 K1_WLa
    s_cmp_ge_u32 s4, 12
    s_cbranch_scc1 K1_MINI
    s_and_b32 s90, s2, 7
    s_lshr_b32 s3, s2, 3
    s_lshr_b32 s5, s90, 2
    s_and_b32 s90, s90, 3
    s_lshl_b32 s90, s90, 5
    s_add_u32 s3, s3, s90
    s_sub_u32 s7, 10127, s3
    s_lshr_b32 s7, s7, 7
    s_mov_b32 s8, 0
    s_movk_i32 s9, 192
    s_mov_b32 s10, 1
    s_mov_b32 s11, 1
    s_mov_b32 s13, 0x05040100
    s_mov_b32 s14, 0x07060302
    s_lshl_b32 s90, s3, 9
    s_sub_u32 s91, 5120000, s90
    s_add_u32 s40, s68, s90
    s_addc_u32 s41, s69, 0
    s_mov_b32 s42, s91
    s_mov_b32 s43, 0x20000
    s_add_u32 s44, s84, s90
    s_addc_u32 s45, s85, 0
    s_mov_b32 s46, s91
    s_mov_b32 s47, 0x20000
    s_mov_b32 s36, s34
    s_mov_b32 s37, s35
    s_mov_b32 s38, 6400000
    s_mov_b32 s39, 0x20000
    s_mov_b32 s48, s34
    s_mov_b32 s49, s35
    s_mov_b32 s50, 9581184
    s_mov_b32 s51, 0x20000
    s_mov_b32 s28, 1
    s_lshl_b32 s6, s4, 15
    s_lshl_b32 s90, s3, 4
    s_add_u32 s6, s6, s90
    s_add_u32 s6, s6, 6466176
    v_and_b32 v12, 15, v3
    v_lshrrev_b32 v13, 4, v3
    s_and_b32 s32, s4, 7
    s_lshr_b32 s91, s32, 1
    s_and_b32 s92, s32, 1
    s_lshl_b32 s93, s91, 6
    s_add_u32 s93, s93, 64
    s_lshl_b32 s94, s5, 5
    s_add_u32 s93, s93, s94
    s_sub_u32 s91, s91, 2
    s_lshl_b32 s91, s91, 5
    s_cmp_lt_u32 s32, 4
    s_cselect_b32 s91, s93, s91
    s_add_u32 s91, s91, s92
    s_lshl_b32 s33, s91, 1
    s_lshl_b32 s32, s32, 10
    v_mul_u32_u24 v78, 0x600, v13
    v_lshl_add_u32 v78, v12, 2, v78
    s_add_u32 s90, s4, 0
    s_mul_i32 s91, s90, 205
    s_lshr_b32 s91, s91, 11
    s_mul_i32 s92, s91, 10
    s_sub_u32 s92, s90, s92
    s_lshl_b32 s93, s92, 6
    v_add_u32 v110, s93, v3
    v_mul_u32_u24 v14, 1639, v110
    v_lshrrev_b32 v14, 16, v14
    v_add_u32 v110, v110, v14
    s_mul_i32 s93, s91, 10496
    s_add_u32 s93, s93, 35840
    v_lshl_add_u32 v110, v110, 4, s93
    s_lshl_b32 s91, s91, 8
    s_add_u32 s91, s91, s2
    s_mul_i32 s91, s91, 10240
    s_lshl_b32 s92, s92, 10
    s_add_u32 s30, s91, s92
    s_add_u32 s90, s4, 16
    s_mul_i32 s91, s90, 205
    s_lshr_b32 s91, s91, 11
    s_mul_i32 s92, s91, 10
    s_sub_u32 s92, s90, s92
    s_lshl_b32 s93, s92, 6
    v_add_u32 v111, s93, v3
    v_mul_u32_u24 v14, 1639, v111
    v_lshrrev_b32 v14, 16, v14
    v_add_u32 v111, v111, v14
    s_mul_i32 s93, s91, 10496
    s_add_u32 s93, s93, 35840
    v_lshl_add_u32 v111, v111, 4, s93
    s_lshl_b32 s91, s91, 8
    s_add_u32 s91, s91, s2
    s_mul_i32 s91, s91, 10240
    s_lshl_b32 s92, s92, 10
    s_add_u32 s31, s91, s92
    s_lshr_b32 s90, s4, 2
    s_and_b32 s91, s4, 3
    v_bfe_u32 v14, v3, 2, 2
    v_and_b32 v15, 3, v3
    v_lshrrev_b32 v26, 1, v14
    v_and_b32 v27, 1, v13
    v_lshl_or_b32 v27, v27, 1, v26
    v_xor_b32 v27, s91, v27
    v_lshlrev_b32 v27, 5, v27
    v_lshl_add_u32 v27, v15, 3, v27
    v_add_u32 v27, 35840, v27
    v_lshl_add_u32 v80, v13, 3, v14
    v_lshl_add_u32 v80, v80, 7, v27
    v_lshl_add_u32 v81, v13, 2, v14
    v_mul_u32_u24 v81, 0x180, v81
    v_add_u32 v81, v81, v27
    s_lshl_b32 s92, s90, 13
    s_add_u32 s92, s92, 138752
    s_cmp_eq_u32 s90, 0
    s_cselect_b32 s92, 68608, s92
    v_lshlrev_b32 v26, 9, v12
    v_add_u32 v26, s92, v26
    v_xor_b32 v112, v13, v12
    v_lshl_add_u32 v112, v112, 4, v26
    v_xor_b32 v113, 64, v112
    s_lshl_b32 s92, s91, 1
    v_lshrrev_b32 v114, 1, v13
    v_add_u32 v114, s92, v114
    v_xor_b32 v114, v114, v12
    v_lshl_add_u32 v114, v114, 4, v26
    v_and_b32 v27, 1, v13
    v_lshl_add_u32 v114, v27, 3, v114
    v_xor_b32 v115, 0x80, v114
    s_lshl_b32 s92, s90, 11
    s_add_u32 s92, s92, 76800
    v_lshlrev_b32 v82, 5, v3
    v_add_u32 v82, s92, v82
    s_lshl_b32 s92, s91, 3
    v_add_u32 v83, s92, v82
    s_mul_i32 s92, s90, 10496
    s_add_u32 s92, s92, 35840
    v_mul_u32_u24 v84, 656, v12
    v_add_u32 v84, s92, v84
    s_lshl_b32 s92, s91, 5
    v_lshl_add_u32 v79, v13, 3, v84
    v_add_u32 v79, s92, v79
    v_lshl_add_u32 v84, v13, 5, v84
    s_lshl_b32 s92, s91, 7
    v_add_u32 v84, s92, v84
    v_lshlrev_b32 v119, 5, v3
    v_and_b32 v12, 15, v3
    v_lshrrev_b32 v13, 4, v3
    v_lshlrev_b32 v89, 11, v12
    v_lshlrev_b32 v90, 2, v13
    s_lshl_b32 s90, s4, 4
    v_add_u32 v85, s90, v13
    s_mov_b32 s90, 10112
    v_mul_lo_u32 v85, v85, s90
    v_lshlrev_b32 v86, 2, v12
    v_add_u32 v86, s8, v86
    v_add_u32 v87, 64, v86
    v_add_u32 v88, 0x80, v86
    v_add_u32 v85, v85, v86
    s_add_u32 s25, s8, s9
    s_mov_b32 s29, 65536
    v_mov_b32 v91, 0
    v_mov_b32 v116, 0
    v_mov_b32 v117, 4
    v_mov_b32 v118, 0x40000000
    buffer_load_ushort v92, v78, s[52:55], s33 offen offset:0
    buffer_load_ushort v93, v78, s[52:55], s33 offen offset:384
    buffer_load_ushort v94, v78, s[52:55], s33 offen offset:768
    buffer_load_ushort v95, v78, s[52:55], s33 offen offset:1152
    s_branch K1_NOG
K1_MINI:
    s_lshr_b32 s3, s2, 3
    s_and_b32 s90, s2, 3
    s_lshl_b32 s90, s90, 5
    s_add_u32 s3, s3, s90
    s_mov_b32 s48, s34
    s_mov_b32 s49, s35
    s_mov_b32 s50, 9581184
    s_mov_b32 s51, 0x20000
    v_lshlrev_b32 v119, 5, v3
    s_and_b32 s72, s4, 14
    s_cmp_lg_u32 s72, 12
    s_cbranch_scc1 K1_NODP
    s_sub_u32 s72, s4, 12
    s_lshl_b32 s72, s72, 6
    v_add_u32 v11, s72, v3
    v_min_u32 v11, 79, v11
    v_lshl_add_u32 v12, v11, 7, s3
    v_min_u32 v12, 9999, v12
    s_mov_b32 s72, 86528
    v_mad_u32_u24 v13, v12, 6, s72
    v_and_b32 v13, -4, v13
    ds_read2_b32 v[14:15], v13 offset0:0 offset1:1
    v_lshlrev_b32 v12, 4, v12
    v_lshlrev_b32 v11, 4, v11
    s_waitcnt lgkmcnt(0)
    v_alignbit_b32 v21, v15, v14, v12
    v_lshrrev_b32 v22, v12, v15
    v_lshlrev_b32 v20, 16, v21
    v_and_b32 v21, 0xffff0000, v21
    v_lshlrev_b32 v22, 16, v22
    ds_write_b128 v11, v[20:23] offset:1600
K1_NODP:
    s_cmp_lg_u32 s4, 14
    s_cbranch_scc1 K1_NOG
    s_lshl_b32 s72, s2, 3
    s_waitcnt vmcnt(9)
    v_lshrrev_b32 v102, 3, v3
    v_add_u32 v102, s72, v102
    v_add_u32 v103, 0x38d1, v102
    v_lshlrev_b32 v103, 16, v103
    v_mul_f32 v107, 0x40490fdb, v103
    v_mov_b32 v108, 0
    v_cvt_pk_bf16_f32 v106, v107, v108
    v_lshlrev_b32 v107, 16, v106
    v_and_b32 v108, 0xffff0000, v106
    v_mul_f32 v107, 0x3e4ccccd, v107
    v_cvt_pk_bf16_f32 v106, v107, v108
    v_lshlrev_b32 v107, 16, v106
    v_and_b32 v108, 0xffff0000, v106
    v_lshlrev_b32 v104, 16, v101
    v_and_b32 v105, 0xffff0000, v101
    v_mul_f32 v104, v104, v103
    v_mul_f32 v105, v105, v103
    v_cvt_pk_bf16_f32 v106, v104, v105
    v_lshlrev_b32 v104, 16, v106
    v_and_b32 v105, 0xffff0000, v106
    v_mul_f32 v104, 0.15915494, v104
    v_mul_f32 v105, 0.15915494, v105
    v_mul_f32 v107, 0.15915494, v107
    v_fract_f32 v104, v104
    v_fract_f32 v105, v105
    v_fract_f32 v107, v107
    v_sin_f32 v104, v104
    v_sin_f32 v105, v105
    v_cos_f32 v107, v107
    v_rcp_f32 v109, v103
    s_nop 0
    v_cvt_pk_bf16_f32 v106, v104, v105
    v_lshlrev_b32 v104, 16, v106
    v_and_b32 v105, 0xffff0000, v106
    v_cvt_pk_bf16_f32 v106, v107, v108
    v_lshlrev_b32 v107, 16, v106
    v_and_b32 v108, 0xffff0000, v106
    v_mul_f32 v104, v104, v109
    v_mul_f32 v105, v105, v109
    v_cvt_pk_bf16_f32 v106, v104, v105
    v_lshlrev_b32 v104, 16, v106
    v_and_b32 v105, 0xffff0000, v106
    v_add_f32 v107, 1.0, v107
    v_cvt_pk_bf16_f32 v106, v107, v108
    v_lshlrev_b32 v107, 16, v106
    v_and_b32 v108, 0xffff0000, v106
    v_mul_f32 v107, 0.5, v107
    v_mul_f32 v104, v104, v107
    v_mul_f32 v105, v105, v107
    v_cvt_pk_bf16_f32 v106, v104, v105
    v_lshlrev_b32 v100, 2, v3
    s_lshl_b32 s72, s72, 5
    s_add_u32 s72, s72, 6400640
    buffer_store_dword v106, v100, s[48:51], s72 offen sc1
    buffer_load_dwordx2 v[126:127], v125, s[64:67], 0 offen sc1
K1_NOG:
    s_barrier
    s_waitcnt vmcnt(0)
    s_barrier
    s_cmp_lg_u32 s4, 14
    s_cbranch_scc1 K1_JOIN
    s_mov_b32 s72, 65536
K1_TL:
    s_waitcnt vmcnt(0)
    v_readfirstlane_b32 s73, v127
    s_nop 3
    s_cmp_lg_u32 s73, 0
    s_cbranch_scc1 K1_TG
    s_sub_u32 s72, s72, 1
    s_cbranch_scc1 K_END
    s_sleep 4
    buffer_load_dwordx2 v[126:127], v125, s[64:67], 0 offen sc1
    s_branch K1_TL
K1_TG:
    v_mov_b32 v125, 163824
    ds_write_b64 v125, v[126:127]
K1_JOIN:
    s_cmp_ge_u32 s4, 12
    s_cbranch_scc1 K1_J2
    ds_read_b64_tr_b16 v[26:27], v80 offset:0
    ds_read_b64_tr_b16 v[28:29], v80 offset:512
    ds_read_b64_tr_b16 v[30:31], v80 offset:4096
    ds_read_b64_tr_b16 v[32:33], v80 offset:4608
    ds_read_b128 v[70:73], v112
    ds_read_b128 v[74:77], v113
    s_waitcnt lgkmcnt(0)
    v_mfma_f32_16x16x32_bf16 v[58:61], v[26:29], v[70:73], 0
    v_mfma_f32_16x16x32_bf16 v[58:61], v[30:33], v[74:77], v[58:61]
    ds_read_b64_tr_b16 v[34:35], v81 offset:8192
    ds_read_b64_tr_b16 v[36:37], v81 offset:14336
    ds_read_b64_tr_b16 v[38:39], v81 offset:20480
    ds_read_b64_tr_b16 v[40:41], v81 offset:26624
    ds_read_b64_tr_b16 v[42:43], v81 offset:8320
    ds_read_b64_tr_b16 v[44:45], v81 offset:14464
    ds_read_b64_tr_b16 v[46:47], v81 offset:20608
    ds_read_b64_tr_b16 v[48:49], v81 offset:26752
    ds_read_b64_tr_b16 v[50:51], v81 offset:8448
    ds_read_b64_tr_b16 v[52:53], v81 offset:14592
    ds_read_b64_tr_b16 v[54:55], v81 offset:20736
    ds_read_b64_tr_b16 v[56:57], v81 offset:26880
    v_cvt_pk_bf16_f32 v104, v58, v59
    v_lshlrev_b32 v58, 16, v104
    v_and_b32 v59, 0xffff0000, v104
    v_cvt_pk_bf16_f32 v104, v60, v61
    v_lshlrev_b32 v60, 16, v104
    v_and_b32 v61, 0xffff0000, v104
    v_mul_f32 v104, 0xbfb8aa3b, v58
    v_mul_f32 v105, 0xbfb8aa3b, v59
    v_mul_f32 v106, 0xbfb8aa3b, v60
    v_mul_f32 v107, 0xbfb8aa3b, v61
    v_exp_f32 v104, v104
    v_exp_f32 v105, v105
    v_exp_f32 v106, v106
    v_exp_f32 v107, v107
    ds_read_b64 v[20:21], v115 offset:0
    ds_read_b64 v[22:23], v114 offset:256
    ds_read_b64 v[24:25], v115 offset:256
    v_add_f32 v104, 1.0, v104
    v_add_f32 v105, 1.0, v105
    v_add_f32 v106, 1.0, v106
    v_add_f32 v107, 1.0, v107
    v_rcp_f32 v104, v104
    v_rcp_f32 v105, v105
    v_rcp_f32 v106, v106
    v_rcp_f32 v107, v107
    v_mul_f32 v58, v58, v104
    v_mul_f32 v59, v59, v105
    v_mul_f32 v60, v60, v106
    v_mul_f32 v61, v61, v107
    v_cvt_pk_bf16_f32 v104, v58, v59
    v_cvt_pk_bf16_f32 v105, v60, v61
    ds_write_b64 v83, v[104:105]
K1_J2:
    v_mov_b32 v125, 163824
    s_lshl_b32 s72, s2, 11
    s_add_u32 s72, s72, 6466176
    s_waitcnt vmcnt(0) lgkmcnt(0)
    s_barrier
    ds_read_b64 v[122:123], v125
    s_cmp_lg_u32 s4, 0
    s_cbranch_scc1 K1_NOPUB2
    s_waitcnt lgkmcnt(0)
    v_mov_b32 v126, v122
    v_mov_b32 v127, v123
    v_mov_b32 v121, v123
    v_mov_b32 v125, v123
    buffer_store_dwordx4 v[120:123], v119, s[48:51], s72 offen sc1
    buffer_store_dwordx4 v[124:127], v119, s[48:51], s72 offen offset:16 sc1
K1_NOPUB2:
    s_cmp_ge_u32 s4, 12
    s_cbranch_scc1 K1_LATE
    ds_read_b128 v[70:73], v82 offset:0
    ds_read_b128 v[74:77], v82 offset:16
    s_waitcnt lgkmcnt(0)
    v_mfma_f32_16x16x32_bf16 v[30:33], v[42:45], v[70:73], 0
    v_mfma_f32_16x16x32_bf16 v[30:33], v[46:49], v[74:77], v[30:33]
    v_mfma_f32_16x16x32_bf16 v[26:29], v[34:37], v[70:73], 0
    v_mfma_f32_16x16x32_bf16 v[26:29], v[38:41], v[74:77], v[26:29]
    v_mfma_f32_16x16x32_bf16 v[58:61], v[50:53], v[70:73], 0
    v_mfma_f32_16x16x32_bf16 v[58:61], v[54:57], v[74:77], v[58:61]
    s_nop 3
    v_cvt_pk_bf16_f32 v10, v30, v31
    v_lshlrev_b32 v30, 16, v10
    v_and_b32 v31, 0xffff0000, v10
    v_lshlrev_b32 v10, 16, v20
    v_and_b32 v11, 0xffff0000, v20
    v_pk_mul_f32 v[10:11], v[10:11], v[30:31]
    v_cvt_pk_bf16_f32 v62, v10, v11
    v_lshlrev_b32 v10, 16, v22
    v_and_b32 v11, 0xffff0000, v22
    v_pk_mul_f32 v[10:11], v[10:11], v[30:31]
    v_cvt_pk_bf16_f32 v63, v10, v11
    v_lshlrev_b32 v10, 16, v24
    v_and_b32 v11, 0xffff0000, v24
    v_pk_mul_f32 v[10:11], v[10:11], v[30:31]
    v_cvt_pk_bf16_f32 v64, v10, v11
    v_cvt_pk_bf16_f32 v65, v58, v59
    ds_write_b128 v84, v[62:65] offset:0
    v_cvt_pk_bf16_f32 v10, v32, v33
    v_lshlrev_b32 v32, 16, v10
    v_and_b32 v33, 0xffff0000, v10
    v_lshlrev_b32 v10, 16, v21
    v_and_b32 v11, 0xffff0000, v21
    v_pk_mul_f32 v[10:11], v[10:11], v[32:33]
    v_cvt_pk_bf16_f32 v66, v10, v11
    v_lshlrev_b32 v10, 16, v23
    v_and_b32 v11, 0xffff0000, v23
    v_pk_mul_f32 v[10:11], v[10:11], v[32:33]
    v_cvt_pk_bf16_f32 v67, v10, v11
    v_lshlrev_b32 v10, 16, v25
    v_and_b32 v11, 0xffff0000, v25
    v_pk_mul_f32 v[10:11], v[10:11], v[32:33]
    v_cvt_pk_bf16_f32 v68, v10, v11
    v_cvt_pk_bf16_f32 v69, v60, v61
    ds_write_b128 v84, v[66:69] offset:16
    v_cvt_pk_bf16_f32 v108, v26, v27
    v_cvt_pk_bf16_f32 v109, v28, v29
    ds_write_b64 v79, v[108:109] offset:512
    s_branch K2_NOFILL
K1_LATE:
    s_and_b32 s90, s2, 7
    s_lshr_b32 s3, s2, 3
    s_lshr_b32 s5, s90, 2
    s_and_b32 s90, s90, 3
    s_lshl_b32 s90, s90, 5
    s_add_u32 s3, s3, s90
    s_sub_u32 s7, 10127, s3
    s_lshr_b32 s7, s7, 7
    s_mov_b32 s8, 0
    s_movk_i32 s9, 192
    s_mov_b32 s10, 1
    s_mov_b32 s11, 1
    s_mov_b32 s13, 0x05040100
    s_mov_b32 s14, 0x07060302
    s_lshl_b32 s90, s3, 9
    s_sub_u32 s91, 5120000, s90
    s_add_u32 s40, s68, s90
    s_addc_u32 s41, s69, 0
    s_mov_b32 s42, s91
    s_mov_b32 s43, 0x20000
    s_add_u32 s44, s84, s90
    s_addc_u32 s45, s85, 0
    s_mov_b32 s46, s91
    s_mov_b32 s47, 0x20000
    s_mov_b32 s36, s34
    s_mov_b32 s37, s35
    s_mov_b32 s38, 6400000
    s_mov_b32 s39, 0x20000
    s_mov_b32 s48, s34
    s_mov_b32 s49, s35
    s_mov_b32 s50, 9581184
    s_mov_b32 s51, 0x20000
    s_mov_b32 s28, 1
    s_lshl_b32 s6, s4, 15
    s_lshl_b32 s90, s3, 4
    s_add_u32 s6, s6, s90
    s_add_u32 s6, s6, 6466176
    v_and_b32 v12, 15, v3
    v_lshrrev_b32 v13, 4, v3
    s_and_b32 s32, s4, 7
    s_lshr_b32 s91, s32, 1
    s_and_b32 s92, s32, 1
    s_lshl_b32 s93, s91, 6
    s_add_u32 s93, s93, 64
    s_lshl_b32 s94, s5, 5
    s_add_u32 s93, s93, s94
    s_sub_u32 s91, s91, 2
    s_lshl_b32 s91, s91, 5
    s_cmp_lt_u32 s32, 4
    s_cselect_b32 s91, s93, s91
    s_add_u32 s91, s91, s92
    s_lshl_b32 s33, s91, 1
    s_lshl_b32 s32, s32, 10
    v_mul_u32_u24 v78, 0x600, v13
    v_lshl_add_u32 v78, v12, 2, v78
    s_add_u32 s90, s4, 0
    s_mul_i32 s91, s90, 205
    s_lshr_b32 s91, s91, 11
    s_mul_i32 s92, s91, 10
    s_sub_u32 s92, s90, s92
    s_lshl_b32 s93, s92, 6
    v_add_u32 v110, s93, v3
    v_mul_u32_u24 v14, 1639, v110
    v_lshrrev_b32 v14, 16, v14
    v_add_u32 v110, v110, v14
    s_mul_i32 s93, s91, 10496
    s_add_u32 s93, s93, 35840
    v_lshl_add_u32 v110, v110, 4, s93
    s_lshl_b32 s91, s91, 8
    s_add_u32 s91, s91, s2
    s_mul_i32 s91, s91, 10240
    s_lshl_b32 s92, s92, 10
    s_add_u32 s30, s91, s92
    s_add_u32 s90, s4, 16
    s_mul_i32 s91, s90, 205
    s_lshr_b32 s91, s91, 11
    s_mul_i32 s92, s91, 10
    s_sub_u32 s92, s90, s92
    s_lshl_b32 s93, s92, 6
    v_add_u32 v111, s93, v3
    v_mul_u32_u24 v14, 1639, v111
    v_lshrrev_b32 v14, 16, v14
    v_add_u32 v111, v111, v14
    s_mul_i32 s93, s91, 10496
    s_add_u32 s93, s93, 35840
    v_lshl_add_u32 v111, v111, 4, s93
    s_lshl_b32 s91, s91, 8
    s_add_u32 s91, s91, s2
    s_mul_i32 s91, s91, 10240
    s_lshl_b32 s92, s92, 10
    s_add_u32 s31, s91, s92
    v_lshlrev_b32 v119, 5, v3
    v_and_b32 v12, 15, v3
    v_lshrrev_b32 v13, 4, v3
    v_lshlrev_b32 v89, 11, v12
    v_lshlrev_b32 v90, 2, v13
    s_lshl_b32 s90, s4, 4
    v_add_u32 v85, s90, v13
    s_mov_b32 s90, 10112
    v_mul_lo_u32 v85, v85, s90
    v_lshlrev_b32 v86, 2, v12
    v_add_u32 v86, s8, v86
    v_add_u32 v87, 64, v86
    v_add_u32 v88, 0x80, v86
    v_add_u32 v85, v85, v86
    s_add_u32 s25, s8, s9
    s_mov_b32 s29, 65536
    v_mov_b32 v91, 0
    v_mov_b32 v116, 0
    v_mov_b32 v117, 4
    v_mov_b32 v118, 0x40000000
    buffer_load_ushort v92, v78, s[52:55], s33 offen offset:0
    buffer_load_ushort v93, v78, s[52:55], s33 offen offset:384
    buffer_load_ushort v94, v78, s[52:55], s33 offen offset:768
    buffer_load_ushort v95, v78, s[52:55], s33 offen offset:1152
    s_branch K2_FILL
K2_PASS:
    v_mbcnt_lo_u32_b32 v3, -1, 0
    v_mbcnt_hi_u32_b32 v3, -1, v3
    v_lshlrev_b32 v2, 4, v3
    v_and_b32 v10, 15, v3
    v_lshrrev_b32 v11, 4, v3
    v_lshlrev_b32 v89, 11, v10
    v_lshlrev_b32 v90, 2, v11
    s_lshl_b32 s90, s4, 4
    v_add_u32 v85, s90, v11
    s_mov_b32 s90, 10112
    v_mul_lo_u32 v85, v85, s90
    v_lshlrev_b32 v86, 2, v10
    v_add_u32 v86, s8, v86
    v_add_u32 v87, 64, v86
    v_add_u32 v88, 0x80, v86
    v_add_u32 v85, v85, v86
    s_add_u32 s25, s8, s9
    s_mov_b32 s29, 65536
    v_mov_b32 v91, 0
    v_mov_b32 v116, 0
    v_mov_b32 v117, 4
    v_mov_b32 v118, 0x40000000
    s_lshr_b32 s91, s2, 3
    s_lshl_b32 s91, s91, 1
    s_lshl_b32 s92, s4, 2
    s_add_u32 s91, s91, s92
    s_add_u32 s92, s91, 0
    s_and_b32 s92, s92, 63
    s_min_u32 s92, s92, 58
    s_lshl_b32 s92, s92, 10
    s_add_u32 s93, s91, 1
    s_and_b32 s93, s93, 63
    s_min_u32 s93, s93, 58
    s_lshl_b32 s93, s93, 10
    s_add_u32 s94, s91, 2
    s_and_b32 s94, s94, 63
    s_min_u32 s94, s94, 58
    s_lshl_b32 s94, s94, 10
    s_add_u32 s95, s91, 3
    s_and_b32 s95, s95, 63
    s_min_u32 s95, s95, 58
    s_lshl_b32 s95, s95, 10
    s_mov_b32 s56, s98
    s_mov_b32 s57, s99
    s_mov_b32 s58, 60000
    s_mov_b32 s59, 0x20000
    s_add_u32 m0, s92, 86528
    s_nop 0
    buffer_load_dwordx4 v2, s[56:59], s92 offen lds
    s_add_u32 m0, s93, 86528
    s_nop 0
    buffer_load_dwordx4 v2, s[56:59], s93 offen lds
    s_add_u32 m0, s94, 86528
    s_nop 0
    buffer_load_dwordx4 v2, s[56:59], s94 offen lds
    s_add_u32 m0, s95, 86528
    s_nop 0
    buffer_load_dwordx4 v2, s[56:59], s95 offen lds
    s_cmp_lt_u32 s4, 12
    s_cbranch_scc1 K2_NOFILL
K2_FILL:
    s_sub_u32 s74, s4, 12
    s_lshl_b32 s74, s74, 10
    v_add_u32 v9, s74, v2
    v_mov_b32 v20, 0
    v_mov_b32 v21, 0
    v_mov_b32 v22, 0
    v_mov_b32 v23, 0
    v_mov_b32 v24, 0x1f32710
    v_mov_b32 v25, 0x1f32710
    v_mov_b32 v26, 0x1f32710
    v_mov_b32 v27, 0x1f32710
    ds_write_b128 v9, v[24:27] offset:19264
    ds_write_b128 v9, v[24:27] offset:23360
    ds_write_b128 v9, v[24:27] offset:27456
    ds_write_b128 v9, v[24:27] offset:31552
    v_lshlrev_b32 v10, 3, v3
    ds_write_b64 v10, v[20:21] offset:0
    v_add_u32 v10, 163328, v2
    s_mov_b64 exec, 3
    ds_write_b128 v10, v[20:23]
    s_mov_b64 exec, 1
    ds_write_b64 v20, v[20:21] offset:1552
    v_mov_b32 v22, 192
    v_mov_b32 v20, 32
    ds_write_b128 v21, v[20:23] offset:1536
    s_mov_b64 exec, -1
    s_waitcnt vmcnt(0)
K2_NOFILL:
    s_waitcnt lgkmcnt(0)
    s_barrier
    s_cmp_eq_u32 s28, 0
    s_cbranch_scc1 K2_POLL
    ds_read_b128 v[8:11], v110
    ds_read_b128 v[12:15], v111
    v_readfirstlane_b32 s96, v122
    v_readfirstlane_b32 s97, v123
    v_lshlrev_b32 v92, 16, v92
    v_lshlrev_b32 v93, 16, v93
    v_lshlrev_b32 v94, 16, v94
    v_lshlrev_b32 v95, 16, v95
    v_add_u32 v4, s32, v2
    s_waitcnt lgkmcnt(1)
    buffer_store_dwordx4 v[8:11], v2, s[36:39], s30 offen sc1
    s_waitcnt lgkmcnt(0)
    buffer_store_dwordx4 v[12:15], v2, s[36:39], s31 offen sc1
    buffer_load_dwordx4 v[96:99], v89, s[48:51], s6 offen sc1
    ds_write_b128 v4, v[92:95] offset:2880
    s_mov_b32 s28, 0
    s_lshl_b32 s74, s2, 3
    s_add_u32 s74, s74, 6990464
    s_waitcnt vmcnt(1)
    s_mov_b64 exec, 1
    ds_add_rtn_u32 v6, v116, v117 offset:1552
    s_waitcnt lgkmcnt(0)
    v_cmp_eq_u32 vcc, 60, v6
    s_mov_b64 exec, vcc
    s_cbranch_execz K2_NOFL2
    buffer_store_dwordx2 v[122:123], v116, s[48:51], s74 offen sc1
    s_mov_b64 exec, -1
    s_waitcnt vmcnt(1)
    s_branch K2_NOFL3
K2_POLL:
    buffer_load_dwordx4 v[96:99], v89, s[48:51], s6 offen sc1
K2_NOFL2:
    s_mov_b64 exec, -1
    s_waitcnt vmcnt(0)
K2_NOFL3:
    v_cmp_ne_u64 vcc, s[96:97], v[98:99]
    s_cmp_eq_u64 vcc, 0
    s_cbranch_scc1 K2_POLLD
    s_sub_u32 s29, s29, 1
    s_cbranch_scc1 K_END
    s_sleep 2
    s_branch K2_POLL
K2_POLLD:
    ds_bpermute_b32 v101, v90, v96 offset:0
    ds_bpermute_b32 v102, v90, v96 offset:16
    ds_bpermute_b32 v103, v90, v96 offset:32
    ds_bpermute_b32 v104, v90, v96 offset:48
    s_mov_b32 s74, 6992512
    s_mov_b32 s75, 7032960
    s_mov_b32 s76, 7073408
    s_mov_b32 s77, 7113856
    s_movk_i32 s78, 0x80
    s_waitcnt lgkmcnt(0)
    v_and_b32 v64, 0xffff, v101
    v_lshrrev_b32 v101, 16, v101
    v_max_u32 v91, v91, v101
    v_min_u32 v101, s25, v101
    v_cmp_lt_u32 s[80:81], v86, v101
    v_cmp_lt_u32 s[88:89], v87, v101
    v_add_u32 v64, v64, v85
    s_nop 0
    v_cndmask_b32 v64, v118, v64, s[80:81]
    s_mov_b64 exec, s[88:89]
    s_cbranch_execz K2_L0
    buffer_load_dword v32, v64, s[48:51], s74 offen offset:64 sc1
K2_L0:
    s_mov_b64 exec, -1
    v_and_b32 v65, 0xffff, v102
    v_lshrrev_b32 v102, 16, v102
    v_max_u32 v91, v91, v102
    v_min_u32 v102, s25, v102
    v_cmp_lt_u32 s[82:83], v86, v102
    v_cmp_lt_u32 s[90:91], v87, v102
    v_add_u32 v65, v65, v85
    s_nop 0
    v_cndmask_b32 v65, v118, v65, s[82:83]
    s_mov_b64 exec, s[90:91]
    s_cbranch_execz K2_L1
    buffer_load_dword v34, v65, s[48:51], s75 offen offset:64 sc1
K2_L1:
    s_mov_b64 exec, -1
    v_and_b32 v66, 0xffff, v103
    v_lshrrev_b32 v103, 16, v103
    v_max_u32 v91, v91, v103
    v_min_u32 v103, s25, v103
    v_cmp_lt_u32 s[84:85], v86, v103
    v_cmp_lt_u32 s[92:93], v87, v103
    v_add_u32 v66, v66, v85
    s_nop 0
    v_cndmask_b32 v66, v118, v66, s[84:85]
    s_mov_b64 exec, s[92:93]
    s_cbranch_execz K2_L2
    buffer_load_dword v36, v66, s[48:51], s76 offen offset:64 sc1
K2_L2:
    s_mov_b64 exec, -1
    v_and_b32 v67, 0xffff, v104
    v_lshrrev_b32 v104, 16, v104
    v_max_u32 v91, v91, v104
    v_min_u32 v104, s25, v104
    v_cmp_lt_u32 s[86:87], v86, v104
    v_cmp_lt_u32 s[94:95], v87, v104
    v_add_u32 v67, v67, v85
    s_nop 0
    v_cndmask_b32 v67, v118, v67, s[86:87]
    s_mov_b64 exec, s[94:95]
    s_cbranch_execz K2_L3
    buffer_load_dword v38, v67, s[48:51], s77 offen offset:64 sc1
K2_L3:
    s_mov_b64 exec, -1
    v_cmp_lt_u32 s[26:27], s78, v91
    s_cmp_lg_u64 s[26:27], 0
    s_cbranch_scc1 K2_X0
K2_X0R:
    buffer_load_dword v24, v64, s[48:51], s74 offen sc1
    buffer_load_dword v26, v65, s[48:51], s75 offen sc1
    buffer_load_dword v28, v66, s[48:51], s76 offen sc1
    buffer_load_dword v30, v67, s[48:51], s77 offen sc1
    s_lshl_b32 s74, s4, 10
    s_add_u32 m0, s74, 146944
    s_add_u32 s74, s74, 6448128
    s_waitcnt vmcnt(3)
    v_lshrrev_b32 v25, 25, v24
    v_lshlrev_b32 v25, 2, v25
    s_mov_b64 exec, s[80:81]
    ds_add_rtn_u32 v56, v25, v117 offset:0
    s_mov_b64 exec, -1
    s_waitcnt vmcnt(2)
    v_lshrrev_b32 v27, 25, v26
    v_lshlrev_b32 v27, 2, v27
    s_mov_b64 exec, s[82:83]
    ds_add_rtn_u32 v57, v27, v117 offset:0
    s_mov_b64 exec, -1
    s_waitcnt vmcnt(1)
    v_lshrrev_b32 v29, 25, v28
    v_lshlrev_b32 v29, 2, v29
    s_mov_b64 exec, s[84:85]
    ds_add_rtn_u32 v58, v29, v117 offset:0
    s_mov_b64 exec, -1
    s_waitcnt vmcnt(0)
    v_lshrrev_b32 v31, 25, v30
    v_lshlrev_b32 v31, 2, v31
    s_mov_b64 exec, s[86:87]
    ds_add_rtn_u32 v59, v31, v117 offset:0
    s_mov_b64 exec, -1
    s_cmp_eq_u64 s[88:89], 0
    s_cbranch_scc1 K2_C4
    v_lshrrev_b32 v33, 25, v32
    v_lshlrev_b32 v33, 2, v33
    s_mov_b64 exec, s[88:89]
    ds_add_rtn_u32 v60, v33, v117 offset:0
    s_mov_b64 exec, -1
K2_C4:
    s_cmp_eq_u64 s[90:91], 0
    s_cbranch_scc1 K2_C5
    v_lshrrev_b32 v35, 25, v34
    v_lshlrev_b32 v35, 2, v35
    s_mov_b64 exec, s[90:91]
    ds_add_rtn_u32 v61, v35, v117 offset:0
    s_mov_b64 exec, -1
K2_C5:
    s_cmp_eq_u64 s[92:93], 0
    s_cbranch_scc1 K2_C6
    v_lshrrev_b32 v37, 25, v36
    v_lshlrev_b32 v37, 2, v37
    s_mov_b64 exec, s[92:93]
    ds_add_rtn_u32 v62, v37, v117 offset:0
    s_mov_b64 exec, -1
K2_C6:
    s_cmp_eq_u64 s[94:95], 0
    s_cbranch_scc1 K2_C7
    v_lshrrev_b32 v39, 25, v38
    v_lshlrev_b32 v39, 2, v39
    s_mov_b64 exec, s[94:95]
    ds_add_rtn_u32 v63, v39, v117 offset:0
    s_mov_b64 exec, -1
K2_C7:
    s_cmp_lg_u64 s[26:27], 0
    s_cbranch_scc1 K2_X1
K2_X1R:
    s_waitcnt lgkmcnt(0)
    s_barrier
    buffer_load_dwordx4 v2, s[48:51], s74 offen lds
    s_cmp_lg_u32 s4, 15
    s_cbranch_scc1 K2_NOGP
    s_lshr_b32 s74, s2, 3
    s_mul_i32 s74, s74, 1536
    s_add_u32 s74, s74, 6400640
    v_mul_u32_u24 v66, 24, v3
    buffer_load_dword v66, v66, s[48:51], s74 offen
    s_and_b32 s74, s2, 0xf8
    s_lshl_b32 s74, s74, 3
    s_add_u32 s74, s74, 6990464
    v_and_b32 v112, 7, v3
    v_lshlrev_b32 v112, 3, v112
    buffer_load_dwordx2 v[114:115], v112, s[48:51], s74 offen sc1
K2_NOGP:
    s_cmp_lg_u32 s4, 0
    s_cbranch_scc1 K2_NOSCAN
    v_lshlrev_b32 v4, 3, v3
    ds_read_b64 v[6:7], v4 offset:0
    v_lshlrev_b32 v5, 1, v3
    v_add_u32 v8, 1, v5
    v_cmp_gt_u32 s[74:75], s7, v5
    v_cmp_gt_u32 s[76:77], s7, v8
    s_waitcnt lgkmcnt(0)
    v_add_u32 v6, 31, v6
    v_lshrrev_b32 v6, 5, v6
    v_max_u32 v6, 1, v6
    v_add_u32 v7, 31, v7
    v_lshrrev_b32 v7, 5, v7
    v_max_u32 v7, 1, v7
    v_cndmask_b32 v6, 0, v6, s[74:75]
    v_cndmask_b32 v7, 0, v7, s[76:77]
    v_add_u32 v10, v6, v7
    v_mov_b32 v11, v10
    s_nop 1
    v_add_u32_dpp v11, v11, v11 row_shr:1 row_mask:0xf bank_mask:0xf bound_ctrl:0
    s_nop 1
    v_add_u32_dpp v11, v11, v11 row_shr:2 row_mask:0xf bank_mask:0xf bound_ctrl:0
    s_nop 1
    v_add_u32_dpp v11, v11, v11 row_shr:4 row_mask:0xf bank_mask:0xf bound_ctrl:0
    s_nop 1
    v_add_u32_dpp v11, v11, v11 row_shr:8 row_mask:0xf bank_mask:0xf bound_ctrl:0
    s_nop 1
    v_add_u32_dpp v11, v11, v11 row_bcast:15 row_mask:0xa bank_mask:0xf
    s_nop 1
    v_add_u32_dpp v11, v11, v11 row_bcast:31 row_mask:0xc bank_mask:0xf
    v_sub_u32 v12, v11, v10
    v_add_u32 v13, v12, v6
    v_lshlrev_b32 v14, 5, v12
    v_lshlrev_b32 v15, 5, v13
    ds_write_b64 v4, v[14:15] offset:1024
    v_lshlrev_b32 v12, 3, v12
    v_lshlrev_b32 v13, 3, v13
    v_lshl_or_b32 v12, v6, 16, v12
    v_lshl_or_b32 v13, v7, 16, v13
    ds_write_b64 v4, v[12:13] offset:512
    v_readlane_b32 s74, v11, 63
    s_nop 3
    v_mov_b32 v14, s74
    ds_write_b32 v116, v14 offset:1548
    s_waitcnt lgkmcnt(0)
K2_NOSCAN:
    s_barrier
    ds_read_b64 v[4:5], v116 offset:1544
    s_mov_b64 exec, s[80:81]
    ds_read_b32 v8, v25 offset:1024
    s_mov_b64 exec, s[82:83]
    ds_read_b32 v9, v27 offset:1024
    s_mov_b64 exec, s[84:85]
    ds_read_b32 v10, v29 offset:1024
    s_mov_b64 exec, s[86:87]
    ds_read_b32 v11, v31 offset:1024
    s_mov_b64 exec, s[88:89]
    ds_read_b32 v12, v33 offset:1024
    s_mov_b64 exec, s[90:91]
    ds_read_b32 v13, v35 offset:1024
    s_mov_b64 exec, s[92:93]
    ds_read_b32 v14, v37 offset:1024
    s_mov_b64 exec, s[94:95]
    ds_read_b32 v15, v39 offset:1024
    s_mov_b64 exec, -1
    s_waitcnt lgkmcnt(0)
    v_readfirstlane_b32 s12, v4
    v_readfirstlane_b32 s79, v5
    s_nop 3
    s_cmp_lg_u32 s9, 192
    s_cbranch_scc1 K2_GO
    s_cmp_gt_u32 s12, 192
    s_cbranch_scc1 K2_SLOW
    s_cmp_le_u32 s79, 511
    s_cbranch_scc1 K2_GO
K2_SLOW:
    s_movk_i32 s9, 48
    s_mov_b32 s11, 0
    s_waitcnt vmcnt(0) lgkmcnt(0)
    s_barrier
    s_branch K2_PASS
K2_GO:
    s_cmp_lg_u32 s4, 15
    s_cbranch_scc1 K2_NOF0
    s_mov_b32 s69, 6990464
    buffer_load_dwordx4 v[92:95], v2, s[48:51], s69 offen sc1
    buffer_load_dwordx4 v[96:99], v2, s[48:51], s69 offen offset:1024 sc1
K2_NOF0:
    s_mov_b64 exec, s[80:81]
    v_add_u32 v8, v8, v56
    ds_write_b32 v8, v24 offset:19264
    s_mov_b64 exec, s[82:83]
    v_add_u32 v9, v9, v57
    ds_write_b32 v9, v26 offset:19264
    s_mov_b64 exec, s[84:85]
    v_add_u32 v10, v10, v58
    ds_write_b32 v10, v28 offset:19264
    s_mov_b64 exec, s[86:87]
    v_add_u32 v11, v11, v59
    ds_write_b32 v11, v30 offset:19264
    s_cmp_eq_u64 s[88:89], 0
    s_cbranch_scc1 K2_P4
    s_mov_b64 exec, s[88:89]
    v_add_u32 v12, v12, v60
    ds_write_b32 v12, v32 offset:19264
K2_P4:
    s_cmp_eq_u64 s[90:91], 0
    s_cbranch_scc1 K2_P5
    s_mov_b64 exec, s[90:91]
    v_add_u32 v13, v13, v61
    ds_write_b32 v13, v34 offset:19264
K2_P5:
    s_cmp_eq_u64 s[92:93], 0
    s_cbranch_scc1 K2_P6
    s_mov_b64 exec, s[92:93]
    v_add_u32 v14, v14, v62
    ds_write_b32 v14, v36 offset:19264
K2_P6:
    s_cmp_eq_u64 s[94:95], 0
    s_cbranch_scc1 K2_P7
    s_mov_b64 exec, s[94:95]
    v_add_u32 v15, v15, v63
    ds_write_b32 v15, v38 offset:19264
K2_P7:
    s_cmp_lg_u64 s[26:27], 0
    s_cbranch_scc1 K2_X2
K2_X2R:
    s_mov_b64 exec, -1
    s_mov_b32 s15, 0
    s_cmp_lg_u32 s4, 15
    s_cbranch_scc1 K2_NOCK
    s_waitcnt vmcnt(2)
    v_cmp_ne_u64 vcc, s[96:97], v[114:115]
    s_cmp_eq_u64 vcc, 0
    s_cselect_b32 s15, 1, 0
    s_lshr_b32 s19, s2, 3
    s_mul_i32 s19, s19, 81920
    s_lshl_b32 s74, s5, 8
    s_add_u32 s19, s19, s74
K2_NOCK:
    v_lshrrev_b32 v112, 1, v3
    v_mul_u32_u24 v112, 640, v112
    v_and_b32 v113, 1, v3
    v_lshl_add_u32 v112, v113, 7, v112
    s_cmp_lg_u32 s15, 1
    s_cbranch_scc1 K2_PFA
    s_add_u32 s74, s19, 0
    buffer_load_dword v113, v112, s[36:39], s74 offen sc1
    s_add_u32 s74, s19, 20480
    buffer_load_dword v113, v112, s[36:39], s74 offen sc1
    s_add_u32 s74, s19, 40960
    buffer_load_dword v113, v112, s[36:39], s74 offen sc1
    s_add_u32 s74, s19, 61440
    buffer_load_dword v113, v112, s[36:39], s74 offen sc1
K2_PFA:
    s_lshl_b32 s74, s4, 10
    v_add_u32 v1, s74, v2
    v_lshrrev_b32 v0, 1, v1
    s_mov_b32 s68, 86528
    s_movk_i32 s69, 640
    s_movk_i32 s70, 14545
    s_movk_i32 s71, 1484
    s_waitcnt lgkmcnt(0)
    s_barrier
    s_lshl_b32 s74, s4, 5
    s_cmp_gt_u32 s74, s79
    s_cbranch_scc1 K2_DD
    ds_read_b128 v[4:7], v1 offset:19264
    s_waitcnt lgkmcnt(0)
    v_lshrrev_b32 v17, 25, v4
    v_lshlrev_b32 v17, 4, v17
    ds_read_b128 v[20:23], v17 offset:1600
    v_and_b32 v36, 0x3fff, v4
    v_mad_u32_u24 v17, v36, 6, s68
    v_and_b32 v17, -4, v17
    ds_read2_b32 v[8:9], v17 offset0:0 offset1:1
    v_and_b32 v37, 0x3fff, v5
    v_mad_u32_u24 v17, v37, 6, s68
    v_and_b32 v17, -4, v17
    ds_read2_b32 v[10:11], v17 offset0:0 offset1:1
    v_and_b32 v38, 0x3fff, v6
    v_mad_u32_u24 v17, v38, 6, s68
    v_and_b32 v17, -4, v17
    ds_read2_b32 v[12:13], v17 offset0:0 offset1:1
    v_and_b32 v39, 0x3fff, v7
    v_mad_u32_u24 v17, v39, 6, s68
    v_and_b32 v17, -4, v17
    ds_read2_b32 v[14:15], v17 offset0:0 offset1:1
    v_bfe_u32 v40, v4, 14, 11
    v_bfe_u32 v41, v5, 14, 11
    v_bfe_u32 v42, v6, 14, 11
    v_bfe_u32 v43, v7, 14, 11
    v_add_lshl_u32 v44, v40, s70, 16
    v_add_lshl_u32 v45, v41, s70, 16
    v_add_lshl_u32 v46, v42, s70, 16
    v_add_lshl_u32 v47, v43, s70, 16
    v_min3_u32 v17, v40, v41, v42
    v_min_u32 v17, v17, v43
    v_cmp_gt_u32 vcc, s71, v17
    s_cbranch_vccnz K2_RARE
K2_RARED:
    v_mul_u32_u24 v36, s69, v36
    v_rcp_f32 v44, v44
    v_lshlrev_b32 v4, 4, v4
    v_mul_u32_u24 v37, s69, v37
    v_rcp_f32 v45, v45
    v_lshlrev_b32 v5, 4, v5
    v_mul_u32_u24 v38, s69, v38
    v_rcp_f32 v46, v46
    v_lshlrev_b32 v6, 4, v6
    v_mul_u32_u24 v39, s69, v39
    v_rcp_f32 v47, v47
    v_lshlrev_b32 v7, 4, v7
    ds_write_b128 v1, v[36:39] offset:19264
    v_lshlrev_b32 v40, 5, v40
    v_lshl_or_b32 v40, v41, 21, v40
    v_lshlrev_b32 v41, 5, v42
    v_lshl_or_b32 v41, v43, 21, v41
    ds_write_b64 v0, v[40:41] offset:11072
    v_add_u32 v1, 16384, v1
    s_waitcnt lgkmcnt(2)
    v_alignbit_b32 v28, v9, v8, v4
    v_lshrrev_b32 v32, v4, v9
    v_lshlrev_b32 v24, 16, v28
    v_and_b32 v28, 0xffff0000, v28
    v_lshlrev_b32 v32, 16, v32
    v_alignbit_b32 v29, v11, v10, v5
    v_lshrrev_b32 v33, v5, v11
    v_lshlrev_b32 v25, 16, v29
    v_and_b32 v29, 0xffff0000, v29
    v_lshlrev_b32 v33, 16, v33
    v_alignbit_b32 v30, v13, v12, v6
    v_lshrrev_b32 v34, v6, v13
    v_lshlrev_b32 v26, 16, v30
    v_and_b32 v30, 0xffff0000, v30
    v_lshlrev_b32 v34, 16, v34
    v_alignbit_b32 v31, v15, v14, v7
    v_lshrrev_b32 v35, v7, v15
    v_lshlrev_b32 v27, 16, v31
    v_and_b32 v31, 0xffff0000, v31
    v_lshlrev_b32 v35, 16, v35
    v_pk_add_f32 v[24:25], v[24:25], v[20:21] op_sel:[0,0] op_sel_hi:[1,0] neg_lo:[0,1] neg_hi:[0,1]
    v_pk_mul_f32 v[24:25], v[24:25], v[44:45]
    v_pk_add_f32 v[26:27], v[26:27], v[20:21] op_sel:[0,0] op_sel_hi:[1,0] neg_lo:[0,1] neg_hi:[0,1]
    v_pk_mul_f32 v[26:27], v[26:27], v[46:47]
    ds_write_b128 v1, v[24:27] offset:19264
    v_pk_add_f32 v[28:29], v[28:29], v[20:21] op_sel:[0,1] op_sel_hi:[1,1] neg_lo:[0,1] neg_hi:[0,1]
    v_pk_mul_f32 v[28:29], v[28:29], v[44:45]
    v_pk_add_f32 v[30:31], v[30:31], v[20:21] op_sel:[0,1] op_sel_hi:[1,1] neg_lo:[0,1] neg_hi:[0,1]
    v_pk_mul_f32 v[30:31], v[30:31], v[46:47]
    ds_write_b128 v1, v[28:31] offset:35648
    v_pk_add_f32 v[32:33], v[32:33], v[22:23] op_sel:[0,0] op_sel_hi:[1,0] neg_lo:[0,1] neg_hi:[0,1]
    v_pk_mul_f32 v[32:33], v[32:33], v[44:45]
    v_pk_add_f32 v[34:35], v[34:35], v[22:23] op_sel:[0,0] op_sel_hi:[1,0] neg_lo:[0,1] neg_hi:[0,1]
    v_pk_mul_f32 v[34:35], v[34:35], v[46:47]
    ds_write_b128 v1, v[32:35] offset:52032
K2_DD:
    s_cmp_lg_u32 s4, 15
    s_cbranch_scc1 K2_FD
    s_mov_b32 s29, 65536
    s_mov_b32 s69, 6990464
    s_cmp_lg_u32 s15, 1
    s_cbranch_scc1 K2_FL1
    s_waitcnt vmcnt(4)
    s_branch K2_FL2
K2_FL:
    buffer_load_dwordx4 v[92:95], v2, s[48:51], s69 offen sc1
    buffer_load_dwordx4 v[96:99], v2, s[48:51], s69 offen offset:1024 sc1
K2_FL1:
    s_waitcnt vmcnt(0)
K2_FL2:
    v_cmp_ne_u64 vcc, s[96:97], v[92:93]
    v_cmp_ne_u64 s[74:75], s[96:97], v[94:95]
    s_or_b64 vcc, vcc, s[74:75]
    v_cmp_ne_u64 s[74:75], s[96:97], v[96:97]
    s_or_b64 vcc, vcc, s[74:75]
    v_cmp_ne_u64 s[74:75], s[96:97], v[98:99]
    s_or_b64 vcc, vcc, s[74:75]
    s_cbranch_scc0 K2_FD
    s_sub_u32 s29, s29, 1
    s_cbranch_scc1 K_END
    s_sleep 2
    s_branch K2_FL
K2_FD:
    v_bfe_u32 v17, v3, 3, 1
    v_bfe_u32 v18, v3, 2, 1
    v_lshrrev_b32 v19, 4, v3
    v_add_u32 v4, 2880, v2
    v_lshlrev_b32 v1, 3, v19
    v_add_u32 v1, 19264, v1
    v_lshlrev_b32 v2, 2, v19
    v_lshl_add_u32 v2, v17, 4, v2
    v_lshl_add_u32 v2, v18, 1, v2
    v_add_u32 v2, 11072, v2
    v_and_b32 v3, 3, v3
    v_lshlrev_b32 v3, 3, v3
    v_add_u32 v3, 99456, v3
M_START:
    s_mov_b32 s70, s4
    s_add_u32 s72, s4, 16
    s_lshl_b32 s76, s4, 2
    v_mov_b32 v20, s76
    ds_read_b32 v14, v20 offset:512
    v_mbcnt_lo_u32_b32 v10, -1, 0
    v_mbcnt_hi_u32_b32 v10, -1, v10
    v_and_b32 v11, 15, v10
    v_lshrrev_b32 v12, 4, v10
    s_lshl_b32 s76, s5, 6
    s_add_u32 s76, s76, 128
    v_lshlrev_b32 v5, 7, v12
    v_lshl_add_u32 v5, v11, 2, v5
    v_add_u32 v5, s76, v5
    v_cmp_eq_u32 vcc, 3, v12
    s_lshl_b32 s76, s5, 8
    v_lshlrev_b32 v0, 4, v11
    v_add_u32 v0, s76, v0
    v_mov_b32 v13, 0x40000000
    v_cndmask_b32 v5, v5, v13, vcc
    s_cmp_eq_u32 s15, 1
    s_cbranch_scc1 K2_NW
    s_waitcnt vmcnt(0)
K2_NW:
    s_waitcnt lgkmcnt(0)
    v_readfirstlane_b32 s71, v14
    v_mov_b32 v36, 0
    v_mov_b32 v37, 0
    v_mov_b32 v38, 0
    v_mov_b32 v39, 0
    v_mov_b32 v40, 0
    v_mov_b32 v41, 0
    v_mov_b32 v42, 0
    v_mov_b32 v43, 0
    v_mov_b32 v44, 0
    v_mov_b32 v45, 0
    v_mov_b32 v46, 0
    v_mov_b32 v47, 0
    s_and_b32 s68, s71, 0xffff
    s_lshr_b32 s69, s71, 16
    s_barrier
    ds_read_b32 v21, v116 offset:1556
    s_lshl_b32 s76, s68, 2
    s_lshl_b32 s77, s68, 1
    v_add_u32 v9, s76, v1
    v_add_u32 v19, s77, v2
    ds_read_u16 v18, v19
    ds_read_u16 v19, v19 offset:32
    ds_read_b64 v[10:11], v9 offset:0
    ds_read_b64 v[12:13], v9 offset:32
    ds_read_b64 v[14:15], v9 offset:64
    ds_read_b64 v[16:17], v9 offset:96
    s_waitcnt lgkmcnt(0)
    v_readfirstlane_b32 s78, v21
    s_cmp_le_u32 s69, 0
    s_cbranch_scc1 M_INIT2
    v_add_u32 v10, v10, v0
    buffer_load_dwordx4 v[48:51], v10, s[36:39], 0 offen sc1
    v_add_u32 v11, v11, v0
    buffer_load_dwordx4 v[52:55], v11, s[36:39], 0 offen sc1
    s_cmp_le_u32 s69, 1
    s_cbranch_scc1 M_INIT2
    v_add_u32 v12, v12, v0
    buffer_load_dwordx4 v[56:59], v12, s[36:39], 0 offen sc1
    v_add_u32 v13, v13, v0
    buffer_load_dwordx4 v[60:63], v13, s[36:39], 0 offen sc1
    s_cmp_le_u32 s69, 2
    s_cbranch_scc1 M_INIT2
    v_add_u32 v14, v14, v0
    buffer_load_dwordx4 v[64:67], v14, s[36:39], 0 offen sc1
    v_add_u32 v15, v15, v0
    buffer_load_dwordx4 v[68:71], v15, s[36:39], 0 offen sc1
    s_cmp_le_u32 s69, 3
    s_cbranch_scc1 M_INIT2
    v_add_u32 v16, v16, v0
    buffer_load_dwordx4 v[72:75], v16, s[36:39], 0 offen sc1
    v_add_u32 v17, v17, v0
    buffer_load_dwordx4 v[76:79], v17, s[36:39], 0 offen sc1
M_INIT2:
    s_cmp_eq_u32 s10, 0
    s_cbranch_scc1 M_IB_BP
    s_lshl_b32 s76, s70, 16
    buffer_load_dword v7, v5, s[40:43], s76 offen
    buffer_load_dword v7, v5, s[40:43], s76 offen
M_IB_BD:
    s_cmp_gt_u32 s78, 56
    s_cbranch_scc1 K2_GALL
K2_GALLD:
    s_waitcnt lgkmcnt(0)
    v_add_u32 v18, v18, v3
    v_add_u32 v19, v19, v3
    ds_read_b64_tr_b16 v[32:33], v18
    ds_read_b64_tr_b16 v[34:35], v19
    ds_read_b64 v[22:23], v9 offset:16384
    ds_read_b64 v[24:25], v9 offset:32768
    ds_read_b64 v[26:27], v9 offset:49152
    ds_read_b32 v8, v20 offset:576
M_DISPF:
    s_cmp_ge_u32 s69, 4
    s_cbranch_scc1 M_KS4F
    s_cmp_ge_u32 s69, 3
    s_cbranch_scc1 M_KS3F
    s_cmp_ge_u32 s69, 2
    s_cbranch_scc1 M_KS2F
    s_cmp_ge_u32 s69, 1
    s_cbranch_scc1 M_KS1F
    s_branch S_START
M_KS4F:
    ds_read_b64 v[10:11], v9 offset:16416
    ds_read_b64 v[12:13], v9 offset:32800
    ds_read_b64 v[14:15], v9 offset:49184
    ds_read_b64 v[16:17], v9 offset:16448
    ds_read_b64 v[18:19], v9 offset:32832
    ds_read_b64 v[20:21], v9 offset:49216
    s_waitcnt lgkmcnt(7)
    v_lshlrev_b32 v28, 16, v32
    v_and_b32 v29, 0xffff0000, v32
    v_pk_mul_f32 v[22:23], v[22:23], v[28:29]
    v_pk_mul_f32 v[24:25], v[24:25], v[28:29]
    v_pk_mul_f32 v[26:27], v[26:27], v[28:29]
    v_cvt_pk_bf16_f32 v36, v22, v23
    v_cvt_pk_bf16_f32 v40, v24, v25
    v_cvt_pk_bf16_f32 v44, v26, v27
    ds_read_b64 v[22:23], v9 offset:16480
    ds_read_b64 v[24:25], v9 offset:32864
    ds_read_b64 v[26:27], v9 offset:49248
    s_waitcnt lgkmcnt(6)
    v_lshlrev_b32 v28, 16, v33
    v_and_b32 v29, 0xffff0000, v33
    v_pk_mul_f32 v[10:11], v[10:11], v[28:29]
    v_pk_mul_f32 v[12:13], v[12:13], v[28:29]
    v_pk_mul_f32 v[14:15], v[14:15], v[28:29]
    v_cvt_pk_bf16_f32 v37, v10, v11
    v_cvt_pk_bf16_f32 v41, v12, v13
    v_cvt_pk_bf16_f32 v45, v14, v15
    s_waitcnt lgkmcnt(3)
    v_lshlrev_b32 v28, 16, v34
    v_and_b32 v29, 0xffff0000, v34
    v_pk_mul_f32 v[16:17], v[16:17], v[28:29]
    v_pk_mul_f32 v[18:19], v[18:19], v[28:29]
    v_pk_mul_f32 v[20:21], v[20:21], v[28:29]
    v_cvt_pk_bf16_f32 v38, v16, v17
    v_cvt_pk_bf16_f32 v42, v18, v19
    v_cvt_pk_bf16_f32 v46, v20, v21
    s_waitcnt lgkmcnt(0)
    v_readfirstlane_b32 s71, v8
    v_lshlrev_b32 v28, 16, v35
    v_and_b32 v29, 0xffff0000, v35
    v_pk_mul_f32 v[22:23], v[22:23], v[28:29]
    v_pk_mul_f32 v[24:25], v[24:25], v[28:29]
    v_pk_mul_f32 v[26:27], v[26:27], v[28:29]
    v_cvt_pk_bf16_f32 v39, v22, v23
    v_cvt_pk_bf16_f32 v43, v24, v25
    v_cvt_pk_bf16_f32 v47, v26, v27
    s_and_b32 s73, s71, 0xffff
    s_lshr_b32 s74, s71, 16
    s_add_u32 s76, s68, 32
    s_sub_u32 s77, s69, 4
    s_cmp_gt_u32 s69, 4
    s_cselect_b32 s73, s76, s73
    s_cselect_b32 s74, s77, s74
    s_cselect_b32 s75, 0, 1
    s_lshl_b32 s76, s73, 2
    s_lshl_b32 s77, s73, 1
    v_add_u32 v9, s76, v1
    v_add_u32 v19, s77, v2
    ds_read_u16 v18, v19
    ds_read_u16 v19, v19 offset:32
    ds_read_b64 v[10:11], v9 offset:0
    ds_read_b64 v[12:13], v9 offset:32
    ds_read_b64 v[14:15], v9 offset:64
    ds_read_b64 v[16:17], v9 offset:96
    s_mov_b32 s68, s73
    s_mov_b32 s69, s74
    s_waitcnt vmcnt(1)
    v_perm_b32 v24, v55, v51, s13
    v_perm_b32 v25, v63, v59, s13
    v_perm_b32 v26, v71, v67, s13
    v_perm_b32 v27, v79, v75, s13
    v_perm_b32 v28, v55, v51, s14
    v_perm_b32 v29, v63, v59, s14
    v_perm_b32 v30, v71, v67, s14
    v_perm_b32 v31, v79, v75, s14
    v_mfma_f32_16x16x32_bf16 v[104:107], v[36:39], v[24:27], 0
    v_mfma_f32_16x16x32_bf16 v[112:115], v[40:43], v[24:27], 0
    v_mfma_f32_16x16x32_bf16 v[120:123], v[44:47], v[24:27], 0
    v_perm_b32 v24, v52, v48, s13
    v_perm_b32 v25, v60, v56, s13
    v_perm_b32 v26, v68, v64, s13
    v_perm_b32 v27, v76, v72, s13
    v_mfma_f32_16x16x32_bf16 v[108:111], v[36:39], v[28:31], 0
    v_mfma_f32_16x16x32_bf16 v[116:119], v[40:43], v[28:31], 0
    v_mfma_f32_16x16x32_bf16 v[124:127], v[44:47], v[28:31], 0
    v_perm_b32 v28, v52, v48, s14
    v_perm_b32 v29, v60, v56, s14
    v_perm_b32 v30, v68, v64, s14
    v_perm_b32 v31, v76, v72, s14
    v_mfma_f32_16x16x32_bf16 v[80:83], v[32:35], v[24:27], 0
    v_perm_b32 v24, v53, v49, s13
    v_perm_b32 v25, v61, v57, s13
    v_perm_b32 v26, v69, v65, s13
    v_perm_b32 v27, v77, v73, s13
    v_mfma_f32_16x16x32_bf16 v[84:87], v[32:35], v[28:31], 0
    v_perm_b32 v28, v53, v49, s14
    v_perm_b32 v29, v61, v57, s14
    v_perm_b32 v30, v69, v65, s14
    v_perm_b32 v31, v77, v73, s14
    v_mfma_f32_16x16x32_bf16 v[88:91], v[32:35], v[24:27], 0
    v_perm_b32 v24, v54, v50, s13
    v_perm_b32 v25, v62, v58, s13
    v_perm_b32 v26, v70, v66, s13
    v_perm_b32 v27, v78, v74, s13
    v_mfma_f32_16x16x32_bf16 v[92:95], v[32:35], v[28:31], 0
    v_perm_b32 v28, v54, v50, s14
    v_perm_b32 v29, v62, v58, s14
    v_perm_b32 v30, v70, v66, s14
    v_perm_b32 v31, v78, v74, s14
    v_mfma_f32_16x16x32_bf16 v[96:99], v[32:35], v[24:27], 0
    s_nop 1
    v_mfma_f32_16x16x32_bf16 v[100:103], v[32:35], v[28:31], 0
    s_cmp_eq_u32 s75, 0
    s_cbranch_scc1 M_CONT
    s_branch M_EPI
M_KS3F:
    ds_read_b64 v[10:11], v9 offset:16416
    ds_read_b64 v[12:13], v9 offset:32800
    ds_read_b64 v[14:15], v9 offset:49184
    ds_read_b64 v[16:17], v9 offset:16448
    ds_read_b64 v[18:19], v9 offset:32832
    ds_read_b64 v[20:21], v9 offset:49216
    s_waitcnt lgkmcnt(7)
    v_lshlrev_b32 v28, 16, v32
    v_and_b32 v29, 0xffff0000, v32
    v_pk_mul_f32 v[22:23], v[22:23], v[28:29]
    v_pk_mul_f32 v[24:25], v[24:25], v[28:29]
    v_pk_mul_f32 v[26:27], v[26:27], v[28:29]
    v_cvt_pk_bf16_f32 v36, v22, v23
    v_cvt_pk_bf16_f32 v40, v24, v25
    v_cvt_pk_bf16_f32 v44, v26, v27
    s_waitcnt lgkmcnt(3)
    v_lshlrev_b32 v28, 16, v33
    v_and_b32 v29, 0xffff0000, v33
    v_pk_mul_f32 v[10:11], v[10:11], v[28:29]
    v_pk_mul_f32 v[12:13], v[12:13], v[28:29]
    v_pk_mul_f32 v[14:15], v[14:15], v[28:29]
    v_cvt_pk_bf16_f32 v37, v10, v11
    v_cvt_pk_bf16_f32 v41, v12, v13
    v_cvt_pk_bf16_f32 v45, v14, v15
    s_waitcnt lgkmcnt(0)
    v_lshlrev_b32 v28, 16, v34
    v_and_b32 v29, 0xffff0000, v34
    v_pk_mul_f32 v[16:17], v[16:17], v[28:29]
    v_pk_mul_f32 v[18:19], v[18:19], v[28:29]
    v_pk_mul_f32 v[20:21], v[20:21], v[28:29]
    v_cvt_pk_bf16_f32 v38, v16, v17
    v_cvt_pk_bf16_f32 v42, v18, v19
    v_cvt_pk_bf16_f32 v46, v20, v21
    v_readfirstlane_b32 s71, v8
    v_mov_b32 v27, 0
    v_mov_b32 v31, 0
    s_nop 1
    s_and_b32 s73, s71, 0xffff
    s_lshr_b32 s74, s71, 16
    s_lshl_b32 s76, s73, 2
    s_lshl_b32 s77, s73, 1
    v_add_u32 v9, s76, v1
    v_add_u32 v19, s77, v2
    ds_read_u16 v18, v19
    ds_read_u16 v19, v19 offset:32
    ds_read_b64 v[10:11], v9 offset:0
    ds_read_b64 v[12:13], v9 offset:32
    ds_read_b64 v[14:15], v9 offset:64
    ds_read_b64 v[16:17], v9 offset:96
    s_mov_b32 s68, s73
    s_mov_b32 s69, s74
    s_waitcnt vmcnt(1)
    v_perm_b32 v24, v55, v51, s13
    v_perm_b32 v25, v63, v59, s13
    v_perm_b32 v26, v71, v67, s13
    v_perm_b32 v28, v55, v51, s14
    v_perm_b32 v29, v63, v59, s14
    v_perm_b32 v30, v71, v67, s14
    v_mfma_f32_16x16x32_bf16 v[104:107], v[36:39], v[24:27], 0
    v_mfma_f32_16x16x32_bf16 v[112:115], v[40:43], v[24:27], 0
    v_mfma_f32_16x16x32_bf16 v[120:123], v[44:47], v[24:27], 0
    v_perm_b32 v24, v52, v48, s13
    v_perm_b32 v25, v60, v56, s13
    v_perm_b32 v26, v68, v64, s13
    v_mfma_f32_16x16x32_bf16 v[108:111], v[36:39], v[28:31], 0
    v_mfma_f32_16x16x32_bf16 v[116:119], v[40:43], v[28:31], 0
    v_mfma_f32_16x16x32_bf16 v[124:127], v[44:47], v[28:31], 0
    v_perm_b32 v28, v52, v48, s14
    v_perm_b32 v29, v60, v56, s14
    v_perm_b32 v30, v68, v64, s14
    v_mfma_f32_16x16x32_bf16 v[80:83], v[32:35], v[24:27], 0
    v_perm_b32 v24, v53, v49, s13
    v_perm_b32 v25, v61, v57, s13
    v_perm_b32 v26, v69, v65, s13
    v_mfma_f32_16x16x32_bf16 v[84:87], v[32:35], v[28:31], 0
    v_perm_b32 v28, v53, v49, s14
    v_perm_b32 v29, v61, v57, s14
    v_perm_b32 v30, v69, v65, s14
    v_mfma_f32_16x16x32_bf16 v[88:91], v[32:35], v[24:27], 0
    v_perm_b32 v24, v54, v50, s13
    v_perm_b32 v25, v62, v58, s13
    v_perm_b32 v26, v70, v66, s13
    v_mfma_f32_16x16x32_bf16 v[92:95], v[32:35], v[28:31], 0
    v_perm_b32 v28, v54, v50, s14
    v_perm_b32 v29, v62, v58, s14
    v_perm_b32 v30, v70, v66, s14
    v_mfma_f32_16x16x32_bf16 v[96:99], v[32:35], v[24:27], 0
    s_nop 1
    v_mfma_f32_16x16x32_bf16 v[100:103], v[32:35], v[28:31], 0
    s_branch M_EPI
M_KS2F:
    ds_read_b64 v[10:11], v9 offset:16416
    ds_read_b64 v[12:13], v9 offset:32800
    ds_read_b64 v[14:15], v9 offset:49184
    s_waitcnt lgkmcnt(4)
    v_lshlrev_b32 v28, 16, v32
    v_and_b32 v29, 0xffff0000, v32
    v_pk_mul_f32 v[22:23], v[22:23], v[28:29]
    v_pk_mul_f32 v[24:25], v[24:25], v[28:29]
    v_pk_mul_f32 v[26:27], v[26:27], v[28:29]
    v_cvt_pk_bf16_f32 v36, v22, v23
    v_cvt_pk_bf16_f32 v40, v24, v25
    v_cvt_pk_bf16_f32 v44, v26, v27
    s_waitcnt lgkmcnt(0)
    v_lshlrev_b32 v28, 16, v33
    v_and_b32 v29, 0xffff0000, v33
    v_pk_mul_f32 v[10:11], v[10:11], v[28:29]
    v_pk_mul_f32 v[12:13], v[12:13], v[28:29]
    v_pk_mul_f32 v[14:15], v[14:15], v[28:29]
    v_cvt_pk_bf16_f32 v37, v10, v11
    v_cvt_pk_bf16_f32 v41, v12, v13
    v_cvt_pk_bf16_f32 v45, v14, v15
    v_readfirstlane_b32 s71, v8
    s_nop 1
    s_and_b32 s73, s71, 0xffff
    s_lshr_b32 s74, s71, 16
    s_lshl_b32 s76, s73, 2
    s_lshl_b32 s77, s73, 1
    v_add_u32 v9, s76, v1
    v_add_u32 v19, s77, v2
    ds_read_u16 v18, v19
    ds_read_u16 v19, v19 offset:32
    ds_read_b64 v[10:11], v9 offset:0
    ds_read_b64 v[12:13], v9 offset:32
    ds_read_b64 v[14:15], v9 offset:64
    ds_read_b64 v[16:17], v9 offset:96
    s_mov_b32 s68, s73
    s_mov_b32 s69, s74
    s_waitcnt vmcnt(1)
    v_perm_b32 v24, v55, v51, s13
    v_perm_b32 v25, v63, v59, s13
    v_perm_b32 v28, v55, v51, s14
    v_perm_b32 v29, v63, v59, s14
    v_mfma_f32_16x16x16_bf16 v[104:107], v[36:37], v[24:25], 0
    v_mfma_f32_16x16x16_bf16 v[112:115], v[40:41], v[24:25], 0
    v_mfma_f32_16x16x16_bf16 v[120:123], v[44:45], v[24:25], 0
    v_perm_b32 v24, v52, v48, s13
    v_perm_b32 v25, v60, v56, s13
    v_mfma_f32_16x16x16_bf16 v[108:111], v[36:37], v[28:29], 0
    v_mfma_f32_16x16x16_bf16 v[116:119], v[40:41], v[28:29], 0
    v_mfma_f32_16x16x16_bf16 v[124:127], v[44:45], v[28:29], 0
    v_perm_b32 v28, v52, v48, s14
    v_perm_b32 v29, v60, v56, s14
    v_mfma_f32_16x16x16_bf16 v[80:83], v[32:33], v[24:25], 0
    v_perm_b32 v24, v53, v49, s13
    v_perm_b32 v25, v61, v57, s13
    v_mfma_f32_16x16x16_bf16 v[84:87], v[32:33], v[28:29], 0
    v_perm_b32 v28, v53, v49, s14
    v_perm_b32 v29, v61, v57, s14
    v_mfma_f32_16x16x16_bf16 v[88:91], v[32:33], v[24:25], 0
    v_perm_b32 v24, v54, v50, s13
    v_perm_b32 v25, v62, v58, s13
    v_mfma_f32_16x16x16_bf16 v[92:95], v[32:33], v[28:29], 0
    v_perm_b32 v28, v54, v50, s14
    v_perm_b32 v29, v62, v58, s14
    v_mfma_f32_16x16x16_bf16 v[96:99], v[32:33], v[24:25], 0
    s_nop 1
    v_mfma_f32_16x16x16_bf16 v[100:103], v[32:33], v[28:29], 0
    s_branch M_EPI
M_KS1F:
    s_waitcnt lgkmcnt(1)
    v_lshlrev_b32 v28, 16, v32
    v_and_b32 v29, 0xffff0000, v32
    v_pk_mul_f32 v[22:23], v[22:23], v[28:29]
    v_pk_mul_f32 v[24:25], v[24:25], v[28:29]
    v_pk_mul_f32 v[26:27], v[26:27], v[28:29]
    v_cvt_pk_bf16_f32 v36, v22, v23
    v_cvt_pk_bf16_f32 v40, v24, v25
    v_cvt_pk_bf16_f32 v44, v26, v27
    s_waitcnt lgkmcnt(0)
    v_readfirstlane_b32 s71, v8
    v_mov_b32 v25, 0
    v_mov_b32 v29, 0
    s_nop 1
    s_and_b32 s73, s71, 0xffff
    s_lshr_b32 s74, s71, 16
    s_lshl_b32 s76, s73, 2
    s_lshl_b32 s77, s73, 1
    v_add_u32 v9, s76, v1
    v_add_u32 v19, s77, v2
    ds_read_u16 v18, v19
    ds_read_u16 v19, v19 offset:32
    ds_read_b64 v[10:11], v9 offset:0
    ds_read_b64 v[12:13], v9 offset:32
    ds_read_b64 v[14:15], v9 offset:64
    ds_read_b64 v[16:17], v9 offset:96
    s_mov_b32 s68, s73
    s_mov_b32 s69, s74
    s_waitcnt vmcnt(1)
    v_perm_b32 v24, v55, v51, s13
    v_perm_b32 v28, v55, v51, s14
    s_nop 0
    v_mfma_f32_16x16x16_bf16 v[104:107], v[36:37], v[24:25], 0
    v_mfma_f32_16x16x16_bf16 v[112:115], v[40:41], v[24:25], 0
    v_mfma_f32_16x16x16_bf16 v[120:123], v[44:45], v[24:25], 0
    v_perm_b32 v24, v52, v48, s13
    s_nop 0
    v_mfma_f32_16x16x16_bf16 v[108:111], v[36:37], v[28:29], 0
    v_mfma_f32_16x16x16_bf16 v[116:119], v[40:41], v[28:29], 0
    v_mfma_f32_16x16x16_bf16 v[124:127], v[44:45], v[28:29], 0
    v_perm_b32 v28, v52, v48, s14
    s_nop 0
    v_mfma_f32_16x16x16_bf16 v[80:83], v[32:33], v[24:25], 0
    v_perm_b32 v24, v53, v49, s13
    s_nop 0
    v_mfma_f32_16x16x16_bf16 v[84:87], v[32:33], v[28:29], 0
    v_perm_b32 v28, v53, v49, s14
    s_nop 0
    v_mfma_f32_16x16x16_bf16 v[88:91], v[32:33], v[24:25], 0
    v_perm_b32 v24, v54, v50, s13
    s_nop 0
    v_mfma_f32_16x16x16_bf16 v[92:95], v[32:33], v[28:29], 0
    v_perm_b32 v28, v54, v50, s14
    s_nop 0
    v_mfma_f32_16x16x16_bf16 v[96:99], v[32:33], v[24:25], 0
    s_nop 1
    v_mfma_f32_16x16x16_bf16 v[100:103], v[32:33], v[28:29], 0
    s_branch M_EPI
M_KS4N:
    ds_read_b64 v[10:11], v9 offset:16416
    ds_read_b64 v[12:13], v9 offset:32800
    ds_read_b64 v[14:15], v9 offset:49184
    ds_read_b64 v[16:17], v9 offset:16448
    ds_read_b64 v[18:19], v9 offset:32832
    ds_read_b64 v[20:21], v9 offset:49216
    s_waitcnt lgkmcnt(6)
    v_lshlrev_b32 v28, 16, v32
    v_and_b32 v29, 0xffff0000, v32
    v_pk_mul_f32 v[22:23], v[22:23], v[28:29]
    v_pk_mul_f32 v[24:25], v[24:25], v[28:29]
    v_pk_mul_f32 v[26:27], v[26:27], v[28:29]
    v_cvt_pk_bf16_f32 v36, v22, v23
    v_cvt_pk_bf16_f32 v40, v24, v25
    v_cvt_pk_bf16_f32 v44, v26, v27
    ds_read_b64 v[22:23], v9 offset:16480
    ds_read_b64 v[24:25], v9 offset:32864
    ds_read_b64 v[26:27], v9 offset:49248
    s_waitcnt lgkmcnt(6)
    v_lshlrev_b32 v28, 16, v33
    v_and_b32 v29, 0xffff0000, v33
    v_pk_mul_f32 v[10:11], v[10:11], v[28:29]
    v_pk_mul_f32 v[12:13], v[12:13], v[28:29]
    v_pk_mul_f32 v[14:15], v[14:15], v[28:29]
    v_cvt_pk_bf16_f32 v37, v10, v11
    v_cvt_pk_bf16_f32 v41, v12, v13
    v_cvt_pk_bf16_f32 v45, v14, v15
    s_waitcnt lgkmcnt(3)
    v_lshlrev_b32 v28, 16, v34
    v_and_b32 v29, 0xffff0000, v34
    v_pk_mul_f32 v[16:17], v[16:17], v[28:29]
    v_pk_mul_f32 v[18:19], v[18:19], v[28:29]
    v_pk_mul_f32 v[20:21], v[20:21], v[28:29]
    v_cvt_pk_bf16_f32 v38, v16, v17
    v_cvt_pk_bf16_f32 v42, v18, v19
    v_cvt_pk_bf16_f32 v46, v20, v21
    s_waitcnt lgkmcnt(0)
    v_lshlrev_b32 v28, 16, v35
    v_and_b32 v29, 0xffff0000, v35
    v_pk_mul_f32 v[22:23], v[22:23], v[28:29]
    v_pk_mul_f32 v[24:25], v[24:25], v[28:29]
    v_pk_mul_f32 v[26:27], v[26:27], v[28:29]
    v_cvt_pk_bf16_f32 v39, v22, v23
    v_cvt_pk_bf16_f32 v43, v24, v25
    v_cvt_pk_bf16_f32 v47, v26, v27
    s_and_b32 s73, s71, 0xffff
    s_lshr_b32 s74, s71, 16
    s_add_u32 s76, s68, 32
    s_sub_u32 s77, s69, 4
    s_cmp_gt_u32 s69, 4
    s_cselect_b32 s73, s76, s73
    s_cselect_b32 s74, s77, s74
    s_cselect_b32 s75, 0, 1
    s_lshl_b32 s76, s73, 2
    s_lshl_b32 s77, s73, 1
    v_add_u32 v9, s76, v1
    v_add_u32 v19, s77, v2
    ds_read_u16 v18, v19
    ds_read_u16 v19, v19 offset:32
    ds_read_b64 v[10:11], v9 offset:0
    ds_read_b64 v[12:13], v9 offset:32
    ds_read_b64 v[14:15], v9 offset:64
    ds_read_b64 v[16:17], v9 offset:96
    s_mov_b32 s68, s73
    s_mov_b32 s69, s74
    s_waitcnt vmcnt(0)
    v_perm_b32 v24, v55, v51, s13
    v_perm_b32 v25, v63, v59, s13
    v_perm_b32 v26, v71, v67, s13
    v_perm_b32 v27, v79, v75, s13
    v_perm_b32 v28, v55, v51, s14
    v_perm_b32 v29, v63, v59, s14
    v_perm_b32 v30, v71, v67, s14
    v_perm_b32 v31, v79, v75, s14
    v_mfma_f32_16x16x32_bf16 v[104:107], v[36:39], v[24:27], v[104:107]
    v_mfma_f32_16x16x32_bf16 v[112:115], v[40:43], v[24:27], v[112:115]
    v_mfma_f32_16x16x32_bf16 v[120:123], v[44:47], v[24:27], v[120:123]
    v_perm_b32 v24, v52, v48, s13
    v_perm_b32 v25, v60, v56, s13
    v_perm_b32 v26, v68, v64, s13
    v_perm_b32 v27, v76, v72, s13
    v_mfma_f32_16x16x32_bf16 v[108:111], v[36:39], v[28:31], v[108:111]
    v_mfma_f32_16x16x32_bf16 v[116:119], v[40:43], v[28:31], v[116:119]
    v_mfma_f32_16x16x32_bf16 v[124:127], v[44:47], v[28:31], v[124:127]
    v_perm_b32 v28, v52, v48, s14
    v_perm_b32 v29, v60, v56, s14
    v_perm_b32 v30, v68, v64, s14
    v_perm_b32 v31, v76, v72, s14
    v_mfma_f32_16x16x32_bf16 v[80:83], v[32:35], v[24:27], v[80:83]
    v_perm_b32 v24, v53, v49, s13
    v_perm_b32 v25, v61, v57, s13
    v_perm_b32 v26, v69, v65, s13
    v_perm_b32 v27, v77, v73, s13
    v_mfma_f32_16x16x32_bf16 v[84:87], v[32:35], v[28:31], v[84:87]
    v_perm_b32 v28, v53, v49, s14
    v_perm_b32 v29, v61, v57, s14
    v_perm_b32 v30, v69, v65, s14
    v_perm_b32 v31, v77, v73, s14
    v_mfma_f32_16x16x32_bf16 v[88:91], v[32:35], v[24:27], v[88:91]
    v_perm_b32 v24, v54, v50, s13
    v_perm_b32 v25, v62, v58, s13
    v_perm_b32 v26, v70, v66, s13
    v_perm_b32 v27, v78, v74, s13
    v_mfma_f32_16x16x32_bf16 v[92:95], v[32:35], v[28:31], v[92:95]
    v_perm_b32 v28, v54, v50, s14
    v_perm_b32 v29, v62, v58, s14
    v_perm_b32 v30, v70, v66, s14
    v_perm_b32 v31, v78, v74, s14
    v_mfma_f32_16x16x32_bf16 v[96:99], v[32:35], v[24:27], v[96:99]
    s_nop 1
    v_mfma_f32_16x16x32_bf16 v[100:103], v[32:35], v[28:31], v[100:103]
    s_cmp_eq_u32 s75, 0
    s_cbranch_scc1 M_CONT
    s_branch M_EPI
M_KS3N:
    ds_read_b64 v[10:11], v9 offset:16416
    ds_read_b64 v[12:13], v9 offset:32800
    ds_read_b64 v[14:15], v9 offset:49184
    ds_read_b64 v[16:17], v9 offset:16448
    ds_read_b64 v[18:19], v9 offset:32832
    ds_read_b64 v[20:21], v9 offset:49216
    s_waitcnt lgkmcnt(6)
    v_lshlrev_b32 v28, 16, v32
    v_and_b32 v29, 0xffff0000, v32
    v_pk_mul_f32 v[22:23], v[22:23], v[28:29]
    v_pk_mul_f32 v[24:25], v[24:25], v[28:29]
    v_pk_mul_f32 v[26:27], v[26:27], v[28:29]
    v_cvt_pk_bf16_f32 v36, v22, v23
    v_cvt_pk_bf16_f32 v40, v24, v25
    v_cvt_pk_bf16_f32 v44, v26, v27
    s_waitcnt lgkmcnt(3)
    v_lshlrev_b32 v28, 16, v33
    v_and_b32 v29, 0xffff0000, v33
    v_pk_mul_f32 v[10:11], v[10:11], v[28:29]
    v_pk_mul_f32 v[12:13], v[12:13], v[28:29]
    v_pk_mul_f32 v[14:15], v[14:15], v[28:29]
    v_cvt_pk_bf16_f32 v37, v10, v11
    v_cvt_pk_bf16_f32 v41, v12, v13
    v_cvt_pk_bf16_f32 v45, v14, v15
    s_waitcnt lgkmcnt(0)
    v_lshlrev_b32 v28, 16, v34
    v_and_b32 v29, 0xffff0000, v34
    v_pk_mul_f32 v[16:17], v[16:17], v[28:29]
    v_pk_mul_f32 v[18:19], v[18:19], v[28:29]
    v_pk_mul_f32 v[20:21], v[20:21], v[28:29]
    v_cvt_pk_bf16_f32 v38, v16, v17
    v_cvt_pk_bf16_f32 v42, v18, v19
    v_cvt_pk_bf16_f32 v46, v20, v21
    v_mov_b32 v27, 0
    v_mov_b32 v31, 0
    s_and_b32 s73, s71, 0xffff
    s_lshr_b32 s74, s71, 16
    s_lshl_b32 s76, s73, 2
    s_lshl_b32 s77, s73, 1
    v_add_u32 v9, s76, v1
    v_add_u32 v19, s77, v2
    ds_read_u16 v18, v19
    ds_read_u16 v19, v19 offset:32
    ds_read_b64 v[10:11], v9 offset:0
    ds_read_b64 v[12:13], v9 offset:32
    ds_read_b64 v[14:15], v9 offset:64
    ds_read_b64 v[16:17], v9 offset:96
    s_mov_b32 s68, s73
    s_mov_b32 s69, s74
    s_waitcnt vmcnt(0)
    v_perm_b32 v24, v55, v51, s13
    v_perm_b32 v25, v63, v59, s13
    v_perm_b32 v26, v71, v67, s13
    v_perm_b32 v28, v55, v51, s14
    v_perm_b32 v29, v63, v59, s14
    v_perm_b32 v30, v71, v67, s14
    v_mfma_f32_16x16x32_bf16 v[104:107], v[36:39], v[24:27], v[104:107]
    v_mfma_f32_16x16x32_bf16 v[112:115], v[40:43], v[24:27], v[112:115]
    v_mfma_f32_16x16x32_bf16 v[120:123], v[44:47], v[24:27], v[120:123]
    v_perm_b32 v24, v52, v48, s13
    v_perm_b32 v25, v60, v56, s13
    v_perm_b32 v26, v68, v64, s13
    v_mfma_f32_16x16x32_bf16 v[108:111], v[36:39], v[28:31], v[108:111]
    v_mfma_f32_16x16x32_bf16 v[116:119], v[40:43], v[28:31], v[116:119]
    v_mfma_f32_16x16x32_bf16 v[124:127], v[44:47], v[28:31], v[124:127]
    v_perm_b32 v28, v52, v48, s14
    v_perm_b32 v29, v60, v56, s14
    v_perm_b32 v30, v68, v64, s14
    v_mfma_f32_16x16x32_bf16 v[80:83], v[32:35], v[24:27], v[80:83]
    v_perm_b32 v24, v53, v49, s13
    v_perm_b32 v25, v61, v57, s13
    v_perm_b32 v26, v69, v65, s13
    v_mfma_f32_16x16x32_bf16 v[84:87], v[32:35], v[28:31], v[84:87]
    v_perm_b32 v28, v53, v49, s14
    v_perm_b32 v29, v61, v57, s14
    v_perm_b32 v30, v69, v65, s14
    v_mfma_f32_16x16x32_bf16 v[88:91], v[32:35], v[24:27], v[88:91]
    v_perm_b32 v24, v54, v50, s13
    v_perm_b32 v25, v62, v58, s13
    v_perm_b32 v26, v70, v66, s13
    v_mfma_f32_16x16x32_bf16 v[92:95], v[32:35], v[28:31], v[92:95]
    v_perm_b32 v28, v54, v50, s14
    v_perm_b32 v29, v62, v58, s14
    v_perm_b32 v30, v70, v66, s14
    v_mfma_f32_16x16x32_bf16 v[96:99], v[32:35], v[24:27], v[96:99]
    s_nop 1
    v_mfma_f32_16x16x32_bf16 v[100:103], v[32:35], v[28:31], v[100:103]
    s_branch M_EPI
M_KS2N:
    ds_read_b64 v[10:11], v9 offset:16416
    ds_read_b64 v[12:13], v9 offset:32800
    ds_read_b64 v[14:15], v9 offset:49184
    s_waitcnt lgkmcnt(3)
    v_lshlrev_b32 v28, 16, v32
    v_and_b32 v29, 0xffff0000, v32
    v_pk_mul_f32 v[22:23], v[22:23], v[28:29]
    v_pk_mul_f32 v[24:25], v[24:25], v[28:29]
    v_pk_mul_f32 v[26:27], v[26:27], v[28:29]
    v_cvt_pk_bf16_f32 v36, v22, v23
    v_cvt_pk_bf16_f32 v40, v24, v25
    v_cvt_pk_bf16_f32 v44, v26, v27
    s_waitcnt lgkmcnt(0)
    v_lshlrev_b32 v28, 16, v33
    v_and_b32 v29, 0xffff0000, v33
    v_pk_mul_f32 v[10:11], v[10:11], v[28:29]
    v_pk_mul_f32 v[12:13], v[12:13], v[28:29]
    v_pk_mul_f32 v[14:15], v[14:15], v[28:29]
    v_cvt_pk_bf16_f32 v37, v10, v11
    v_cvt_pk_bf16_f32 v41, v12, v13
    v_cvt_pk_bf16_f32 v45, v14, v15
    s_and_b32 s73, s71, 0xffff
    s_lshr_b32 s74, s71, 16
    s_lshl_b32 s76, s73, 2
    s_lshl_b32 s77, s73, 1
    v_add_u32 v9, s76, v1
    v_add_u32 v19, s77, v2
    ds_read_u16 v18, v19
    ds_read_u16 v19, v19 offset:32
    ds_read_b64 v[10:11], v9 offset:0
    ds_read_b64 v[12:13], v9 offset:32
    ds_read_b64 v[14:15], v9 offset:64
    ds_read_b64 v[16:17], v9 offset:96
    s_mov_b32 s68, s73
    s_mov_b32 s69, s74
    s_waitcnt vmcnt(0)
    v_perm_b32 v24, v55, v51, s13
    v_perm_b32 v25, v63, v59, s13
    v_perm_b32 v28, v55, v51, s14
    v_perm_b32 v29, v63, v59, s14
    v_mfma_f32_16x16x16_bf16 v[104:107], v[36:37], v[24:25], v[104:107]
    v_mfma_f32_16x16x16_bf16 v[112:115], v[40:41], v[24:25], v[112:115]
    v_mfma_f32_16x16x16_bf16 v[120:123], v[44:45], v[24:25], v[120:123]
    v_perm_b32 v24, v52, v48, s13
    v_perm_b32 v25, v60, v56, s13
    v_mfma_f32_16x16x16_bf16 v[108:111], v[36:37], v[28:29], v[108:111]
    v_mfma_f32_16x16x16_bf16 v[116:119], v[40:41], v[28:29], v[116:119]
    v_mfma_f32_16x16x16_bf16 v[124:127], v[44:45], v[28:29], v[124:127]
    v_perm_b32 v28, v52, v48, s14
    v_perm_b32 v29, v60, v56, s14
    v_mfma_f32_16x16x16_bf16 v[80:83], v[32:33], v[24:25], v[80:83]
    v_perm_b32 v24, v53, v49, s13
    v_perm_b32 v25, v61, v57, s13
    v_mfma_f32_16x16x16_bf16 v[84:87], v[32:33], v[28:29], v[84:87]
    v_perm_b32 v28, v53, v49, s14
    v_perm_b32 v29, v61, v57, s14
    v_mfma_f32_16x16x16_bf16 v[88:91], v[32:33], v[24:25], v[88:91]
    v_perm_b32 v24, v54, v50, s13
    v_perm_b32 v25, v62, v58, s13
    v_mfma_f32_16x16x16_bf16 v[92:95], v[32:33], v[28:29], v[92:95]
    v_perm_b32 v28, v54, v50, s14
    v_perm_b32 v29, v62, v58, s14
    v_mfma_f32_16x16x16_bf16 v[96:99], v[32:33], v[24:25], v[96:99]
    s_nop 1
    v_mfma_f32_16x16x16_bf16 v[100:103], v[32:33], v[28:29], v[100:103]
    s_branch M_EPI
M_KS1N:
    s_waitcnt lgkmcnt(0)
    v_lshlrev_b32 v28, 16, v32
    v_and_b32 v29, 0xffff0000, v32
    v_pk_mul_f32 v[22:23], v[22:23], v[28:29]
    v_pk_mul_f32 v[24:25], v[24:25], v[28:29]
    v_pk_mul_f32 v[26:27], v[26:27], v[28:29]
    v_cvt_pk_bf16_f32 v36, v22, v23
    v_cvt_pk_bf16_f32 v40, v24, v25
    v_cvt_pk_bf16_f32 v44, v26, v27
    s_waitcnt lgkmcnt(0)
    v_mov_b32 v25, 0
    v_mov_b32 v29, 0
    s_and_b32 s73, s71, 0xffff
    s_lshr_b32 s74, s71, 16
    s_lshl_b32 s76, s73, 2
    s_lshl_b32 s77, s73, 1
    v_add_u32 v9, s76, v1
    v_add_u32 v19, s77, v2
    ds_read_u16 v18, v19
    ds_read_u16 v19, v19 offset:32
    ds_read_b64 v[10:11], v9 offset:0
    ds_read_b64 v[12:13], v9 offset:32
    ds_read_b64 v[14:15], v9 offset:64
    ds_read_b64 v[16:17], v9 offset:96
    s_mov_b32 s68, s73
    s_mov_b32 s69, s74
    s_waitcnt vmcnt(0)
    v_perm_b32 v24, v55, v51, s13
    v_perm_b32 v28, v55, v51, s14
    s_nop 0
    v_mfma_f32_16x16x16_bf16 v[104:107], v[36:37], v[24:25], v[104:107]
    v_mfma_f32_16x16x16_bf16 v[112:115], v[40:41], v[24:25], v[112:115]
    v_mfma_f32_16x16x16_bf16 v[120:123], v[44:45], v[24:25], v[120:123]
    v_perm_b32 v24, v52, v48, s13
    s_nop 0
    v_mfma_f32_16x16x16_bf16 v[108:111], v[36:37], v[28:29], v[108:111]
    v_mfma_f32_16x16x16_bf16 v[116:119], v[40:41], v[28:29], v[116:119]
    v_mfma_f32_16x16x16_bf16 v[124:127], v[44:45], v[28:29], v[124:127]
    v_perm_b32 v28, v52, v48, s14
    s_nop 0
    v_mfma_f32_16x16x16_bf16 v[80:83], v[32:33], v[24:25], v[80:83]
    v_perm_b32 v24, v53, v49, s13
    s_nop 0
    v_mfma_f32_16x16x16_bf16 v[84:87], v[32:33], v[28:29], v[84:87]
    v_perm_b32 v28, v53, v49, s14
    s_nop 0
    v_mfma_f32_16x16x16_bf16 v[88:91], v[32:33], v[24:25], v[88:91]
    v_perm_b32 v24, v54, v50, s13
    s_nop 0
    v_mfma_f32_16x16x16_bf16 v[92:95], v[32:33], v[28:29], v[92:95]
    v_perm_b32 v28, v54, v50, s14
    s_nop 0
    v_mfma_f32_16x16x16_bf16 v[96:99], v[32:33], v[24:25], v[96:99]
    s_nop 1
    v_mfma_f32_16x16x16_bf16 v[100:103], v[32:33], v[28:29], v[100:103]
    s_branch M_EPI
M_CONT:
    s_waitcnt lgkmcnt(0)
    v_add_u32 v18, v18, v3
    v_add_u32 v19, v19, v3
    ds_read_b64_tr_b16 v[32:33], v18
    ds_read_b64_tr_b16 v[34:35], v19
    ds_read_b64 v[22:23], v9 offset:16384
    ds_read_b64 v[24:25], v9 offset:32768
    ds_read_b64 v[26:27], v9 offset:49152
    v_add_u32 v10, v10, v0
    buffer_load_dwordx4 v[48:51], v10, s[36:39], 0 offen sc1
    v_add_u32 v11, v11, v0
    buffer_load_dwordx4 v[52:55], v11, s[36:39], 0 offen sc1
    s_cmp_le_u32 s69, 1
    s_cbranch_scc1 M_CD
    v_add_u32 v12, v12, v0
    buffer_load_dwordx4 v[56:59], v12, s[36:39], 0 offen sc1
    v_add_u32 v13, v13, v0
    buffer_load_dwordx4 v[60:63], v13, s[36:39], 0 offen sc1
    s_cmp_le_u32 s69, 2
    s_cbranch_scc1 M_CD
    v_add_u32 v14, v14, v0
    buffer_load_dwordx4 v[64:67], v14, s[36:39], 0 offen sc1
    v_add_u32 v15, v15, v0
    buffer_load_dwordx4 v[68:71], v15, s[36:39], 0 offen sc1
    s_cmp_le_u32 s69, 3
    s_cbranch_scc1 M_CD
    v_add_u32 v16, v16, v0
    buffer_load_dwordx4 v[72:75], v16, s[36:39], 0 offen sc1
    v_add_u32 v17, v17, v0
    buffer_load_dwordx4 v[76:79], v17, s[36:39], 0 offen sc1
    s_branch M_KS4N
M_CD:
    s_cmp_ge_u32 s69, 3
    s_cbranch_scc1 M_KS3N
    s_cmp_ge_u32 s69, 2
    s_cbranch_scc1 M_KS2N
    s_branch M_KS1N
M_EPI:
    v_mov_b32 v20, 1536
    v_mov_b32 v21, 1
    s_mov_b64 exec, 1
    ds_add_rtn_u32 v8, v20, v21
    s_mov_b64 exec, -1
    ds_read_b128 v[36:39], v4 offset:0
    ds_read_b128 v[40:43], v4 offset:1024
    ds_read_b128 v[44:47], v4 offset:2048
    ds_read_b128 v[28:31], v4 offset:3072
    s_waitcnt lgkmcnt(5)
    v_add_u32 v18, v18, v3
    v_add_u32 v19, v19, v3
    ds_read_b64_tr_b16 v[32:33], v18
    ds_read_b64_tr_b16 v[34:35], v19
    ds_read_b64 v[22:23], v9 offset:16384
    ds_read_b64 v[24:25], v9 offset:32768
    ds_read_b64 v[26:27], v9 offset:49152
    s_cmp_eq_u32 s10, 0
    s_cbranch_scc1 M_EBS
    v_lshlrev_b32 v20, 16, v7
    v_and_b32 v21, 0xffff0000, v7
M_EB:
    s_cmp_le_u32 s69, 0
    s_cbranch_scc1 M_EL
    v_add_u32 v10, v10, v0
    buffer_load_dwordx4 v[48:51], v10, s[36:39], 0 offen sc1
    v_add_u32 v11, v11, v0
    buffer_load_dwordx4 v[52:55], v11, s[36:39], 0 offen sc1
    s_cmp_le_u32 s69, 1
    s_cbranch_scc1 M_EL
    v_add_u32 v12, v12, v0
    buffer_load_dwordx4 v[56:59], v12, s[36:39], 0 offen sc1
    v_add_u32 v13, v13, v0
    buffer_load_dwordx4 v[60:63], v13, s[36:39], 0 offen sc1
    s_cmp_le_u32 s69, 2
    s_cbranch_scc1 M_EL
    v_add_u32 v14, v14, v0
    buffer_load_dwordx4 v[64:67], v14, s[36:39], 0 offen sc1
    v_add_u32 v15, v15, v0
    buffer_load_dwordx4 v[68:71], v15, s[36:39], 0 offen sc1
    s_cmp_le_u32 s69, 3
    s_cbranch_scc1 M_EL
    v_add_u32 v16, v16, v0
    buffer_load_dwordx4 v[72:75], v16, s[36:39], 0 offen sc1
    v_add_u32 v17, v17, v0
    buffer_load_dwordx4 v[76:79], v17, s[36:39], 0 offen sc1
M_EL:
    s_cmp_eq_u32 s10, 0
    s_cbranch_scc1 M_EB2_BP
    s_lshl_b32 s76, s72, 16
    buffer_load_dword v7, v5, s[40:43], s76 offen
M_EB2_BD:
    s_waitcnt lgkmcnt(5)
    v_readfirstlane_b32 s78, v8
    v_pk_mul_f32 v[10:11], v[36:37], v[88:89]
    v_pk_mul_f32 v[12:13], v[40:41], v[92:93]
    v_pk_fma_f32 v[10:11], v[38:39], v[90:91], v[10:11]
    v_pk_fma_f32 v[12:13], v[42:43], v[94:95], v[12:13]
    v_pk_fma_f32 v[10:11], v[44:45], v[112:113], v[10:11]
    v_pk_fma_f32 v[12:13], v[28:29], v[116:117], v[12:13]
    v_pk_fma_f32 v[10:11], v[46:47], v[114:115], v[10:11]
    v_pk_fma_f32 v[12:13], v[30:31], v[118:119], v[12:13]
    v_add_f32 v10, v10, v11
    v_add_f32 v12, v12, v13
    v_mov_b32 v11, v10
    v_mov_b32 v13, v12
    v_pk_mul_f32 v[16:17], v[36:37], v[80:81]
    v_pk_mul_f32 v[18:19], v[40:41], v[84:85]
    v_pk_fma_f32 v[16:17], v[38:39], v[82:83], v[16:17]
    v_pk_fma_f32 v[18:19], v[42:43], v[86:87], v[18:19]
    v_pk_fma_f32 v[16:17], v[44:45], v[104:105], v[16:17]
    v_pk_fma_f32 v[18:19], v[28:29], v[108:109], v[18:19]
    v_pk_fma_f32 v[16:17], v[46:47], v[106:107], v[16:17]
    v_pk_fma_f32 v[18:19], v[30:31], v[110:111], v[18:19]
    v_add_f32 v14, v16, v17
    v_add_f32 v15, v18, v19
    v_pk_mul_f32 v[16:17], v[36:37], v[96:97]
    v_pk_mul_f32 v[18:19], v[40:41], v[100:101]
    v_pk_fma_f32 v[16:17], v[38:39], v[98:99], v[16:17]
    v_pk_fma_f32 v[18:19], v[42:43], v[102:103], v[18:19]
    v_pk_fma_f32 v[16:17], v[44:45], v[120:121], v[16:17]
    v_pk_fma_f32 v[18:19], v[28:29], v[124:125], v[18:19]
    v_pk_fma_f32 v[16:17], v[46:47], v[122:123], v[16:17]
    v_pk_fma_f32 v[18:19], v[30:31], v[126:127], v[18:19]
    v_add_f32 v16, v16, v17
    v_add_f32 v18, v18, v19
    v_permlane32_swap_b32 v10, v11
    v_permlane32_swap_b32 v12, v13
    v_permlane32_swap_b32 v14, v16
    v_permlane32_swap_b32 v15, v18
    v_add_f32 v10, v10, v11
    v_add_f32 v12, v12, v13
    v_add_f32 v14, v14, v16
    v_add_f32 v15, v15, v18
    s_nop 1
    v_permlane16_swap_b32 v14, v10
    v_permlane16_swap_b32 v15, v12
    v_add_f32 v20, v20, v14
    v_add_f32 v21, v21, v15
    v_add_f32 v20, v20, v10
    v_add_f32 v21, v21, v12
    s_lshl_b32 s76, s70, 16
    s_mov_b32 s70, s72
    s_min_u32 s72, s78, 127
    s_lshl_b32 s77, s72, 2
    v_mov_b32 v13, s77
    ds_read_b32 v8, v13 offset:512
    s_cmp_eq_u32 s11, 0
    s_cbranch_scc1 M_EP
    v_cvt_pk_bf16_f32 v30, v20, v21
    buffer_store_dword v30, v5, s[44:47], s76 offen
M_ED:
    s_cmp_ge_u32 s69, 4
    s_cbranch_scc1 M_KS4F
    s_cmp_ge_u32 s69, 3
    s_cbranch_scc1 M_KS3F
    s_cmp_ge_u32 s69, 2
    s_cbranch_scc1 M_KS2F
    s_cmp_ge_u32 s69, 1
    s_cbranch_scc1 M_KS1F
    s_branch S_START
S_START:
    v_mov_b32 v9, 1540
    v_mov_b32 v10, 1
    s_waitcnt lgkmcnt(0)
    s_mov_b64 exec, 1
    ds_add_rtn_u32 v8, v9, v10
    s_mov_b64 exec, -1
    v_mbcnt_lo_u32_b32 v10, -1, 0
    v_mbcnt_hi_u32_b32 v10, -1, v10
    v_and_b32 v11, 15, v10
    v_lshrrev_b32 v12, 4, v10
    v_lshlrev_b32 v0, 2, v11
    v_lshrrev_b32 v13, 1, v12
    v_and_b32 v12, 1, v12
    v_lshl_add_u32 v5, v13, 6, v0
    v_lshl_add_u32 v5, v12, 1, v5
    s_waitcnt lgkmcnt(0)
    v_readfirstlane_b32 s78, v8
    s_nop 3
    s_lshl_b32 s70, s78, 1
    s_add_u32 s70, s70, s5
    s_min_u32 s70, s70, 127
    s_add_u32 s78, s78, 1
    s_lshl_b32 s72, s78, 1
    s_add_u32 s72, s72, s5
    s_min_u32 s72, s72, 127
    s_lshl_b32 s76, s70, 2
    s_lshl_b32 s77, s72, 2
    v_mov_b32 v9, s76
    v_mov_b32 v20, s77
    ds_read_b32 v11, v9 offset:512
    s_waitcnt lgkmcnt(0)
    v_readfirstlane_b32 s71, v11
    s_nop 3
    s_and_b32 s68, s71, 0xffff
    s_lshr_b32 s69, s71, 16
    s_lshl_b32 s76, s68, 2
    s_lshl_b32 s77, s68, 1
    v_add_u32 v9, s76, v1
    v_add_u32 v19, s77, v2
    ds_read_u16 v18, v19
    ds_read_u16 v19, v19 offset:32
    ds_read_b64 v[10:11], v9 offset:0
    ds_read_b64 v[12:13], v9 offset:32
    ds_read_b64 v[14:15], v9 offset:64
    ds_read_b64 v[16:17], v9 offset:96
    s_waitcnt lgkmcnt(0)
    v_add_u32 v18, v18, v3
    v_add_u32 v19, v19, v3
    ds_read_b64_tr_b16 v[32:33], v18
    ds_read_b64_tr_b16 v[34:35], v19
    ds_read_b32 v8, v20 offset:512
    s_cmp_le_u32 s69, 0
    s_cbranch_scc1 S_INIT2
    v_add_u32 v10, v10, v0
    buffer_load_dword v48, v10, s[36:39], 0 offen offset:512
    buffer_load_dword v49, v10, s[36:39], 0 offen offset:576
    v_add_u32 v11, v11, v0
    buffer_load_dword v50, v11, s[36:39], 0 offen offset:512
    buffer_load_dword v51, v11, s[36:39], 0 offen offset:576
    s_cmp_le_u32 s69, 1
    s_cbranch_scc1 S_INIT2
    v_add_u32 v12, v12, v0
    buffer_load_dword v52, v12, s[36:39], 0 offen offset:512
    buffer_load_dword v53, v12, s[36:39], 0 offen offset:576
    v_add_u32 v13, v13, v0
    buffer_load_dword v54, v13, s[36:39], 0 offen offset:512
    buffer_load_dword v55, v13, s[36:39], 0 offen offset:576
    s_cmp_le_u32 s69, 2
    s_cbranch_scc1 S_INIT2
    v_add_u32 v14, v14, v0
    buffer_load_dword v56, v14, s[36:39], 0 offen offset:512
    buffer_load_dword v57, v14, s[36:39], 0 offen offset:576
    v_add_u32 v15, v15, v0
    buffer_load_dword v58, v15, s[36:39], 0 offen offset:512
    buffer_load_dword v59, v15, s[36:39], 0 offen offset:576
    s_cmp_le_u32 s69, 3
    s_cbranch_scc1 S_INIT2
    v_add_u32 v16, v16, v0
    buffer_load_dword v60, v16, s[36:39], 0 offen offset:512
    buffer_load_dword v61, v16, s[36:39], 0 offen offset:576
    v_add_u32 v17, v17, v0
    buffer_load_dword v62, v17, s[36:39], 0 offen offset:512
    buffer_load_dword v63, v17, s[36:39], 0 offen offset:576
S_INIT2:
    s_cmp_eq_u32 s10, 0
    s_cbranch_scc1 S_IB_BP
    s_lshl_b32 s76, s70, 16
    buffer_load_ushort v7, v5, s[40:43], s76 offen
    buffer_load_ushort v7, v5, s[40:43], s76 offen
S_IB_BD:
S_DISPF:
    s_cmp_ge_u32 s69, 4
    s_cbranch_scc1 S_KS4F
    s_cmp_ge_u32 s69, 3
    s_cbranch_scc1 S_KS3F
    s_cmp_ge_u32 s69, 2
    s_cbranch_scc1 S_KS2F
    s_cmp_ge_u32 s69, 1
    s_cbranch_scc1 S_KS1F
    s_branch K2_PASSEND
S_KS4F:
    s_cmp_gt_u32 s69, 4
    s_cbranch_scc1 S_KS4F_NC
    v_mov_b32 v20, 1540
    v_mov_b32 v21, 1
    s_mov_b64 exec, 1
    ds_add_rtn_u32 v8, v20, v21
    s_mov_b64 exec, -1
    s_waitcnt lgkmcnt(0)
    v_readfirstlane_b32 s78, v8
    s_nop 3
    s_lshl_b32 s72, s78, 1
    s_add_u32 s72, s72, s5
    s_min_u32 s72, s72, 127
    s_lshl_b32 s77, s72, 2
    v_mov_b32 v20, s77
    ds_read_b32 v8, v20 offset:512
    s_waitcnt lgkmcnt(0)
    v_readfirstlane_b32 s71, v8
    s_nop 1
S_KS4F_NC:
    s_waitcnt lgkmcnt(0)
    s_nop 1
    s_and_b32 s73, s71, 0xffff
    s_lshr_b32 s74, s71, 16
    s_add_u32 s76, s68, 32
    s_sub_u32 s77, s69, 4
    s_cmp_gt_u32 s69, 4
    s_cselect_b32 s73, s76, s73
    s_cselect_b32 s74, s77, s74
    s_cselect_b32 s75, 0, 1
    s_lshl_b32 s76, s73, 2
    s_lshl_b32 s77, s73, 1
    v_add_u32 v9, s76, v1
    v_add_u32 v19, s77, v2
    ds_read_u16 v18, v19
    ds_read_u16 v19, v19 offset:32
    ds_read_b64 v[10:11], v9 offset:0
    ds_read_b64 v[12:13], v9 offset:32
    ds_read_b64 v[14:15], v9 offset:64
    ds_read_b64 v[16:17], v9 offset:96
    s_mov_b32 s68, s73
    s_mov_b32 s69, s74
    s_waitcnt vmcnt(1)
    v_perm_b32 v24, v50, v48, s13
    v_perm_b32 v25, v54, v52, s13
    v_perm_b32 v26, v58, v56, s13
    v_perm_b32 v27, v62, v60, s13
    v_perm_b32 v28, v50, v48, s14
    v_perm_b32 v29, v54, v52, s14
    v_perm_b32 v30, v58, v56, s14
    v_perm_b32 v31, v62, v60, s14
    v_mfma_f32_16x16x32_bf16 v[80:83], v[32:35], v[24:27], 0
    v_perm_b32 v24, v51, v49, s13
    v_perm_b32 v25, v55, v53, s13
    v_perm_b32 v26, v59, v57, s13
    v_perm_b32 v27, v63, v61, s13
    v_mfma_f32_16x16x32_bf16 v[84:87], v[32:35], v[28:31], 0
    v_perm_b32 v28, v51, v49, s14
    v_perm_b32 v29, v55, v53, s14
    v_perm_b32 v30, v59, v57, s14
    v_perm_b32 v31, v63, v61, s14
    v_mfma_f32_16x16x32_bf16 v[88:91], v[32:35], v[24:27], 0
    s_nop 1
    v_mfma_f32_16x16x32_bf16 v[92:95], v[32:35], v[28:31], 0
    s_cmp_eq_u32 s75, 0
    s_cbranch_scc1 S_CONT
    s_branch S_EPI
S_KS3F:
    v_mov_b32 v20, 1540
    v_mov_b32 v21, 1
    s_mov_b64 exec, 1
    ds_add_rtn_u32 v8, v20, v21
    s_mov_b64 exec, -1
    s_waitcnt lgkmcnt(0)
    v_readfirstlane_b32 s78, v8
    s_nop 3
    s_lshl_b32 s72, s78, 1
    s_add_u32 s72, s72, s5
    s_min_u32 s72, s72, 127
    s_lshl_b32 s77, s72, 2
    v_mov_b32 v20, s77
    ds_read_b32 v8, v20 offset:512
    s_waitcnt lgkmcnt(0)
    v_readfirstlane_b32 s71, v8
    s_nop 1
    v_mov_b32 v27, 0
    v_mov_b32 v31, 0
    s_nop 1
    s_and_b32 s73, s71, 0xffff
    s_lshr_b32 s74, s71, 16
    s_lshl_b32 s76, s73, 2
    s_lshl_b32 s77, s73, 1
    v_add_u32 v9, s76, v1
    v_add_u32 v19, s77, v2
    ds_read_u16 v18, v19
    ds_read_u16 v19, v19 offset:32
    ds_read_b64 v[10:11], v9 offset:0
    ds_read_b64 v[12:13], v9 offset:32
    ds_read_b64 v[14:15], v9 offset:64
    ds_read_b64 v[16:17], v9 offset:96
    s_mov_b32 s68, s73
    s_mov_b32 s69, s74
    s_waitcnt vmcnt(1)
    v_perm_b32 v24, v50, v48, s13
    v_perm_b32 v25, v54, v52, s13
    v_perm_b32 v26, v58, v56, s13
    v_perm_b32 v28, v50, v48, s14
    v_perm_b32 v29, v54, v52, s14
    v_perm_b32 v30, v58, v56, s14
    v_mfma_f32_16x16x32_bf16 v[80:83], v[32:35], v[24:27], 0
    v_perm_b32 v24, v51, v49, s13
    v_perm_b32 v25, v55, v53, s13
    v_perm_b32 v26, v59, v57, s13
    v_mfma_f32_16x16x32_bf16 v[84:87], v[32:35], v[28:31], 0
    v_perm_b32 v28, v51, v49, s14
    v_perm_b32 v29, v55, v53, s14
    v_perm_b32 v30, v59, v57, s14
    v_mfma_f32_16x16x32_bf16 v[88:91], v[32:35], v[24:27], 0
    s_nop 1
    v_mfma_f32_16x16x32_bf16 v[92:95], v[32:35], v[28:31], 0
    s_branch S_EPI
S_KS2F:
    v_mov_b32 v20, 1540
    v_mov_b32 v21, 1
    s_mov_b64 exec, 1
    ds_add_rtn_u32 v8, v20, v21
    s_mov_b64 exec, -1
    s_waitcnt lgkmcnt(0)
    v_readfirstlane_b32 s78, v8
    s_nop 3
    s_lshl_b32 s72, s78, 1
    s_add_u32 s72, s72, s5
    s_min_u32 s72, s72, 127
    s_lshl_b32 s77, s72, 2
    v_mov_b32 v20, s77
    ds_read_b32 v8, v20 offset:512
    s_waitcnt lgkmcnt(0)
    v_readfirstlane_b32 s71, v8
    s_nop 1
    s_nop 1
    s_and_b32 s73, s71, 0xffff
    s_lshr_b32 s74, s71, 16
    s_lshl_b32 s76, s73, 2
    s_lshl_b32 s77, s73, 1
    v_add_u32 v9, s76, v1
    v_add_u32 v19, s77, v2
    ds_read_u16 v18, v19
    ds_read_u16 v19, v19 offset:32
    ds_read_b64 v[10:11], v9 offset:0
    ds_read_b64 v[12:13], v9 offset:32
    ds_read_b64 v[14:15], v9 offset:64
    ds_read_b64 v[16:17], v9 offset:96
    s_mov_b32 s68, s73
    s_mov_b32 s69, s74
    s_waitcnt vmcnt(1)
    v_perm_b32 v24, v50, v48, s13
    v_perm_b32 v25, v54, v52, s13
    v_perm_b32 v28, v50, v48, s14
    v_perm_b32 v29, v54, v52, s14
    v_mfma_f32_16x16x16_bf16 v[80:83], v[32:33], v[24:25], 0
    v_perm_b32 v24, v51, v49, s13
    v_perm_b32 v25, v55, v53, s13
    v_mfma_f32_16x16x16_bf16 v[84:87], v[32:33], v[28:29], 0
    v_perm_b32 v28, v51, v49, s14
    v_perm_b32 v29, v55, v53, s14
    v_mfma_f32_16x16x16_bf16 v[88:91], v[32:33], v[24:25], 0
    s_nop 1
    v_mfma_f32_16x16x16_bf16 v[92:95], v[32:33], v[28:29], 0
    s_branch S_EPI
S_KS1F:
    v_mov_b32 v20, 1540
    v_mov_b32 v21, 1
    s_mov_b64 exec, 1
    ds_add_rtn_u32 v8, v20, v21
    s_mov_b64 exec, -1
    s_waitcnt lgkmcnt(0)
    v_readfirstlane_b32 s78, v8
    s_nop 3
    s_lshl_b32 s72, s78, 1
    s_add_u32 s72, s72, s5
    s_min_u32 s72, s72, 127
    s_lshl_b32 s77, s72, 2
    v_mov_b32 v20, s77
    ds_read_b32 v8, v20 offset:512
    s_waitcnt lgkmcnt(0)
    v_readfirstlane_b32 s71, v8
    s_nop 1
    v_mov_b32 v25, 0
    v_mov_b32 v29, 0
    s_nop 1
    s_and_b32 s73, s71, 0xffff
    s_lshr_b32 s74, s71, 16
    s_lshl_b32 s76, s73, 2
    s_lshl_b32 s77, s73, 1
    v_add_u32 v9, s76, v1
    v_add_u32 v19, s77, v2
    ds_read_u16 v18, v19
    ds_read_u16 v19, v19 offset:32
    ds_read_b64 v[10:11], v9 offset:0
    ds_read_b64 v[12:13], v9 offset:32
    ds_read_b64 v[14:15], v9 offset:64
    ds_read_b64 v[16:17], v9 offset:96
    s_mov_b32 s68, s73
    s_mov_b32 s69, s74
    s_waitcnt vmcnt(1)
    v_perm_b32 v24, v50, v48, s13
    v_perm_b32 v28, v50, v48, s14
    s_nop 0
    v_mfma_f32_16x16x16_bf16 v[80:83], v[32:33], v[24:25], 0
    v_perm_b32 v24, v51, v49, s13
    s_nop 0
    v_mfma_f32_16x16x16_bf16 v[84:87], v[32:33], v[28:29], 0
    v_perm_b32 v28, v51, v49, s14
    s_nop 0
    v_mfma_f32_16x16x16_bf16 v[88:91], v[32:33], v[24:25], 0
    s_nop 1
    v_mfma_f32_16x16x16_bf16 v[92:95], v[32:33], v[28:29], 0
    s_branch S_EPI
S_KS4N:
    s_cmp_gt_u32 s69, 4
    s_cbranch_scc1 S_KS4N_NC
    v_mov_b32 v20, 1540
    v_mov_b32 v21, 1
    s_mov_b64 exec, 1
    ds_add_rtn_u32 v8, v20, v21
    s_mov_b64 exec, -1
    s_waitcnt lgkmcnt(0)
    v_readfirstlane_b32 s78, v8
    s_nop 3
    s_lshl_b32 s72, s78, 1
    s_add_u32 s72, s72, s5
    s_min_u32 s72, s72, 127
    s_lshl_b32 s77, s72, 2
    v_mov_b32 v20, s77
    ds_read_b32 v8, v20 offset:512
    s_waitcnt lgkmcnt(0)
    v_readfirstlane_b32 s71, v8
    s_nop 1
S_KS4N_NC:
    s_waitcnt lgkmcnt(0)
    s_and_b32 s73, s71, 0xffff
    s_lshr_b32 s74, s71, 16
    s_add_u32 s76, s68, 32
    s_sub_u32 s77, s69, 4
    s_cmp_gt_u32 s69, 4
    s_cselect_b32 s73, s76, s73
    s_cselect_b32 s74, s77, s74
    s_cselect_b32 s75, 0, 1
    s_lshl_b32 s76, s73, 2
    s_lshl_b32 s77, s73, 1
    v_add_u32 v9, s76, v1
    v_add_u32 v19, s77, v2
    ds_read_u16 v18, v19
    ds_read_u16 v19, v19 offset:32
    ds_read_b64 v[10:11], v9 offset:0
    ds_read_b64 v[12:13], v9 offset:32
    ds_read_b64 v[14:15], v9 offset:64
    ds_read_b64 v[16:17], v9 offset:96
    s_mov_b32 s68, s73
    s_mov_b32 s69, s74
    s_waitcnt vmcnt(0)
    v_perm_b32 v24, v50, v48, s13
    v_perm_b32 v25, v54, v52, s13
    v_perm_b32 v26, v58, v56, s13
    v_perm_b32 v27, v62, v60, s13
    v_perm_b32 v28, v50, v48, s14
    v_perm_b32 v29, v54, v52, s14
    v_perm_b32 v30, v58, v56, s14
    v_perm_b32 v31, v62, v60, s14
    v_mfma_f32_16x16x32_bf16 v[80:83], v[32:35], v[24:27], v[80:83]
    v_perm_b32 v24, v51, v49, s13
    v_perm_b32 v25, v55, v53, s13
    v_perm_b32 v26, v59, v57, s13
    v_perm_b32 v27, v63, v61, s13
    v_mfma_f32_16x16x32_bf16 v[84:87], v[32:35], v[28:31], v[84:87]
    v_perm_b32 v28, v51, v49, s14
    v_perm_b32 v29, v55, v53, s14
    v_perm_b32 v30, v59, v57, s14
    v_perm_b32 v31, v63, v61, s14
    v_mfma_f32_16x16x32_bf16 v[88:91], v[32:35], v[24:27], v[88:91]
    s_nop 1
    v_mfma_f32_16x16x32_bf16 v[92:95], v[32:35], v[28:31], v[92:95]
    s_cmp_eq_u32 s75, 0
    s_cbranch_scc1 S_CONT
    s_branch S_EPI
S_KS3N:
    v_mov_b32 v20, 1540
    v_mov_b32 v21, 1
    s_mov_b64 exec, 1
    ds_add_rtn_u32 v8, v20, v21
    s_mov_b64 exec, -1
    s_waitcnt lgkmcnt(0)
    v_readfirstlane_b32 s78, v8
    s_nop 3
    s_lshl_b32 s72, s78, 1
    s_add_u32 s72, s72, s5
    s_min_u32 s72, s72, 127
    s_lshl_b32 s77, s72, 2
    v_mov_b32 v20, s77
    ds_read_b32 v8, v20 offset:512
    s_waitcnt lgkmcnt(0)
    v_readfirstlane_b32 s71, v8
    s_nop 1
    v_mov_b32 v27, 0
    v_mov_b32 v31, 0
    s_and_b32 s73, s71, 0xffff
    s_lshr_b32 s74, s71, 16
    s_lshl_b32 s76, s73, 2
    s_lshl_b32 s77, s73, 1
    v_add_u32 v9, s76, v1
    v_add_u32 v19, s77, v2
    ds_read_u16 v18, v19
    ds_read_u16 v19, v19 offset:32
    ds_read_b64 v[10:11], v9 offset:0
    ds_read_b64 v[12:13], v9 offset:32
    ds_read_b64 v[14:15], v9 offset:64
    ds_read_b64 v[16:17], v9 offset:96
    s_mov_b32 s68, s73
    s_mov_b32 s69, s74
    s_waitcnt vmcnt(0)
    v_perm_b32 v24, v50, v48, s13
    v_perm_b32 v25, v54, v52, s13
    v_perm_b32 v26, v58, v56, s13
    v_perm_b32 v28, v50, v48, s14
    v_perm_b32 v29, v54, v52, s14
    v_perm_b32 v30, v58, v56, s14
    v_mfma_f32_16x16x32_bf16 v[80:83], v[32:35], v[24:27], v[80:83]
    v_perm_b32 v24, v51, v49, s13
    v_perm_b32 v25, v55, v53, s13
    v_perm_b32 v26, v59, v57, s13
    v_mfma_f32_16x16x32_bf16 v[84:87], v[32:35], v[28:31], v[84:87]
    v_perm_b32 v28, v51, v49, s14
    v_perm_b32 v29, v55, v53, s14
    v_perm_b32 v30, v59, v57, s14
    v_mfma_f32_16x16x32_bf16 v[88:91], v[32:35], v[24:27], v[88:91]
    s_nop 1
    v_mfma_f32_16x16x32_bf16 v[92:95], v[32:35], v[28:31], v[92:95]
    s_branch S_EPI
S_KS2N:
    v_mov_b32 v20, 1540
    v_mov_b32 v21, 1
    s_mov_b64 exec, 1
    ds_add_rtn_u32 v8, v20, v21
    s_mov_b64 exec, -1
    s_waitcnt lgkmcnt(0)
    v_readfirstlane_b32 s78, v8
    s_nop 3
    s_lshl_b32 s72, s78, 1
    s_add_u32 s72, s72, s5
    s_min_u32 s72, s72, 127
    s_lshl_b32 s77, s72, 2
    v_mov_b32 v20, s77
    ds_read_b32 v8, v20 offset:512
    s_waitcnt lgkmcnt(0)
    v_readfirstlane_b32 s71, v8
    s_nop 1
    s_and_b32 s73, s71, 0xffff
    s_lshr_b32 s74, s71, 16
    s_lshl_b32 s76, s73, 2
    s_lshl_b32 s77, s73, 1
    v_add_u32 v9, s76, v1
    v_add_u32 v19, s77, v2
    ds_read_u16 v18, v19
    ds_read_u16 v19, v19 offset:32
    ds_read_b64 v[10:11], v9 offset:0
    ds_read_b64 v[12:13], v9 offset:32
    ds_read_b64 v[14:15], v9 offset:64
    ds_read_b64 v[16:17], v9 offset:96
    s_mov_b32 s68, s73
    s_mov_b32 s69, s74
    s_waitcnt vmcnt(0)
    v_perm_b32 v24, v50, v48, s13
    v_perm_b32 v25, v54, v52, s13
    v_perm_b32 v28, v50, v48, s14
    v_perm_b32 v29, v54, v52, s14
    v_mfma_f32_16x16x16_bf16 v[80:83], v[32:33], v[24:25], v[80:83]
    v_perm_b32 v24, v51, v49, s13
    v_perm_b32 v25, v55, v53, s13
    v_mfma_f32_16x16x16_bf16 v[84:87], v[32:33], v[28:29], v[84:87]
    v_perm_b32 v28, v51, v49, s14
    v_perm_b32 v29, v55, v53, s14
    v_mfma_f32_16x16x16_bf16 v[88:91], v[32:33], v[24:25], v[88:91]
    s_nop 1
    v_mfma_f32_16x16x16_bf16 v[92:95], v[32:33], v[28:29], v[92:95]
    s_branch S_EPI
S_KS1N:
    v_mov_b32 v20, 1540
    v_mov_b32 v21, 1
    s_mov_b64 exec, 1
    ds_add_rtn_u32 v8, v20, v21
    s_mov_b64 exec, -1
    s_waitcnt lgkmcnt(0)
    v_readfirstlane_b32 s78, v8
    s_nop 3
    s_lshl_b32 s72, s78, 1
    s_add_u32 s72, s72, s5
    s_min_u32 s72, s72, 127
    s_lshl_b32 s77, s72, 2
    v_mov_b32 v20, s77
    ds_read_b32 v8, v20 offset:512
    s_waitcnt lgkmcnt(0)
    v_readfirstlane_b32 s71, v8
    s_nop 1
    v_mov_b32 v25, 0
    v_mov_b32 v29, 0
    s_and_b32 s73, s71, 0xffff
    s_lshr_b32 s74, s71, 16
    s_lshl_b32 s76, s73, 2
    s_lshl_b32 s77, s73, 1
    v_add_u32 v9, s76, v1
    v_add_u32 v19, s77, v2
    ds_read_u16 v18, v19
    ds_read_u16 v19, v19 offset:32
    ds_read_b64 v[10:11], v9 offset:0
    ds_read_b64 v[12:13], v9 offset:32
    ds_read_b64 v[14:15], v9 offset:64
    ds_read_b64 v[16:17], v9 offset:96
    s_mov_b32 s68, s73
    s_mov_b32 s69, s74
    s_waitcnt vmcnt(0)
    v_perm_b32 v24, v50, v48, s13
    v_perm_b32 v28, v50, v48, s14
    s_nop 0
    v_mfma_f32_16x16x16_bf16 v[80:83], v[32:33], v[24:25], v[80:83]
    v_perm_b32 v24, v51, v49, s13
    s_nop 0
    v_mfma_f32_16x16x16_bf16 v[84:87], v[32:33], v[28:29], v[84:87]
    v_perm_b32 v28, v51, v49, s14
    s_nop 0
    v_mfma_f32_16x16x16_bf16 v[88:91], v[32:33], v[24:25], v[88:91]
    s_nop 1
    v_mfma_f32_16x16x16_bf16 v[92:95], v[32:33], v[28:29], v[92:95]
    s_branch S_EPI
S_CONT:
    s_waitcnt lgkmcnt(0)
    v_add_u32 v18, v18, v3
    v_add_u32 v19, v19, v3
    ds_read_b64_tr_b16 v[32:33], v18
    ds_read_b64_tr_b16 v[34:35], v19
    v_add_u32 v10, v10, v0
    buffer_load_dword v48, v10, s[36:39], 0 offen offset:512
    buffer_load_dword v49, v10, s[36:39], 0 offen offset:576
    v_add_u32 v11, v11, v0
    buffer_load_dword v50, v11, s[36:39], 0 offen offset:512
    buffer_load_dword v51, v11, s[36:39], 0 offen offset:576
    s_cmp_le_u32 s69, 1
    s_cbranch_scc1 S_CD
    v_add_u32 v12, v12, v0
    buffer_load_dword v52, v12, s[36:39], 0 offen offset:512
    buffer_load_dword v53, v12, s[36:39], 0 offen offset:576
    v_add_u32 v13, v13, v0
    buffer_load_dword v54, v13, s[36:39], 0 offen offset:512
    buffer_load_dword v55, v13, s[36:39], 0 offen offset:576
    s_cmp_le_u32 s69, 2
    s_cbranch_scc1 S_CD
    v_add_u32 v14, v14, v0
    buffer_load_dword v56, v14, s[36:39], 0 offen offset:512
    buffer_load_dword v57, v14, s[36:39], 0 offen offset:576
    v_add_u32 v15, v15, v0
    buffer_load_dword v58, v15, s[36:39], 0 offen offset:512
    buffer_load_dword v59, v15, s[36:39], 0 offen offset:576
    s_cmp_le_u32 s69, 3
    s_cbranch_scc1 S_CD
    v_add_u32 v16, v16, v0
    buffer_load_dword v60, v16, s[36:39], 0 offen offset:512
    buffer_load_dword v61, v16, s[36:39], 0 offen offset:576
    v_add_u32 v17, v17, v0
    buffer_load_dword v62, v17, s[36:39], 0 offen offset:512
    buffer_load_dword v63, v17, s[36:39], 0 offen offset:576
    s_branch S_KS4N
S_CD:
    s_cmp_ge_u32 s69, 3
    s_cbranch_scc1 S_KS3N
    s_cmp_ge_u32 s69, 2
    s_cbranch_scc1 S_KS2N
    s_branch S_KS1N
S_EPI:
    s_nop 3
    ds_read_b128 v[36:39], v4 offset:4096
    ds_read_b128 v[40:43], v4 offset:5120
    ds_read_b128 v[44:47], v4 offset:6144
    ds_read_b128 v[28:31], v4 offset:7168
    s_waitcnt lgkmcnt(4)
    v_add_u32 v18, v18, v3
    v_add_u32 v19, v19, v3
    ds_read_b64_tr_b16 v[32:33], v18
    ds_read_b64_tr_b16 v[34:35], v19
    s_cmp_eq_u32 s10, 0
    s_cbranch_scc1 S_EBS
    v_lshlrev_b32 v20, 16, v7
S_EB:
    s_cmp_le_u32 s69, 0
    s_cbranch_scc1 S_EL
    v_add_u32 v10, v10, v0
    buffer_load_dword v48, v10, s[36:39], 0 offen offset:512
    buffer_load_dword v49, v10, s[36:39], 0 offen offset:576
    v_add_u32 v11, v11, v0
    buffer_load_dword v50, v11, s[36:39], 0 offen offset:512
    buffer_load_dword v51, v11, s[36:39], 0 offen offset:576
    s_cmp_le_u32 s69, 1
    s_cbranch_scc1 S_EL
    v_add_u32 v12, v12, v0
    buffer_load_dword v52, v12, s[36:39], 0 offen offset:512
    buffer_load_dword v53, v12, s[36:39], 0 offen offset:576
    v_add_u32 v13, v13, v0
    buffer_load_dword v54, v13, s[36:39], 0 offen offset:512
    buffer_load_dword v55, v13, s[36:39], 0 offen offset:576
    s_cmp_le_u32 s69, 2
    s_cbranch_scc1 S_EL
    v_add_u32 v14, v14, v0
    buffer_load_dword v56, v14, s[36:39], 0 offen offset:512
    buffer_load_dword v57, v14, s[36:39], 0 offen offset:576
    v_add_u32 v15, v15, v0
    buffer_load_dword v58, v15, s[36:39], 0 offen offset:512
    buffer_load_dword v59, v15, s[36:39], 0 offen offset:576
    s_cmp_le_u32 s69, 3
    s_cbranch_scc1 S_EL
    v_add_u32 v16, v16, v0
    buffer_load_dword v60, v16, s[36:39], 0 offen offset:512
    buffer_load_dword v61, v16, s[36:39], 0 offen offset:576
    v_add_u32 v17, v17, v0
    buffer_load_dword v62, v17, s[36:39], 0 offen offset:512
    buffer_load_dword v63, v17, s[36:39], 0 offen offset:576
S_EL:
    s_cmp_eq_u32 s10, 0
    s_cbranch_scc1 S_EB2_BP
    s_lshl_b32 s76, s72, 16
    buffer_load_ushort v7, v5, s[40:43], s76 offen
S_EB2_BD:
    s_waitcnt lgkmcnt(2)
    v_pk_mul_f32 v[10:11], v[36:37], v[80:81]
    v_pk_mul_f32 v[12:13], v[40:41], v[84:85]
    v_pk_mul_f32 v[14:15], v[44:45], v[88:89]
    v_pk_mul_f32 v[16:17], v[28:29], v[92:93]
    v_pk_fma_f32 v[10:11], v[38:39], v[82:83], v[10:11]
    v_pk_fma_f32 v[12:13], v[42:43], v[86:87], v[12:13]
    v_pk_fma_f32 v[14:15], v[46:47], v[90:91], v[14:15]
    v_pk_fma_f32 v[16:17], v[30:31], v[94:95], v[16:17]
    v_add_f32 v10, v10, v11
    v_add_f32 v12, v12, v13
    v_add_f32 v14, v14, v15
    v_add_f32 v16, v16, v17
    s_nop 1
    v_permlane32_swap_b32 v10, v14
    v_permlane32_swap_b32 v12, v16
    v_add_f32 v10, v10, v14
    v_add_f32 v12, v12, v16
    s_nop 1
    v_permlane16_swap_b32 v10, v12
    v_add_f32 v20, v20, v10
    v_add_f32 v20, v20, v12
    s_lshl_b32 s76, s70, 16
    s_mov_b32 s70, s72
    s_cmp_eq_u32 s11, 0
    s_cbranch_scc1 S_EP
    v_cvt_pk_bf16_f32 v30, v20, v20
    buffer_store_short v30, v5, s[44:47], s76 offen
S_ED:
    s_cmp_ge_u32 s69, 4
    s_cbranch_scc1 S_KS4F
    s_cmp_ge_u32 s69, 3
    s_cbranch_scc1 S_KS3F
    s_cmp_ge_u32 s69, 2
    s_cbranch_scc1 S_KS2F
    s_cmp_ge_u32 s69, 1
    s_cbranch_scc1 S_KS1F
    s_branch K2_PASSEND
K2_PASSEND:
    s_cmp_lg_u32 s11, 0
    s_cbranch_scc1 K_END
    s_add_u32 s8, s8, 48
    s_mov_b32 s10, 0
    s_add_u32 s74, s8, 48
    s_cmp_le_u32 s12, s74
    s_cselect_b32 s11, 1, 0
    s_waitcnt vmcnt(0) lgkmcnt(0)
    s_barrier
    s_branch K2_PASS
K_END:
    s_endpgm
K2_X0:
    v_cmp_lt_u32 vcc, v88, v101
    s_mov_b64 exec, vcc
    buffer_load_dword v68, v64, s[48:51], s74 offen offset:128 sc1
    s_mov_b64 exec, -1
    v_cmp_lt_u32 vcc, v88, v102
    s_mov_b64 exec, vcc
    buffer_load_dword v72, v65, s[48:51], s75 offen offset:128 sc1
    s_mov_b64 exec, -1
    v_cmp_lt_u32 vcc, v88, v103
    s_mov_b64 exec, vcc
    buffer_load_dword v76, v66, s[48:51], s76 offen offset:128 sc1
    s_mov_b64 exec, -1
    v_cmp_lt_u32 vcc, v88, v104
    s_mov_b64 exec, vcc
    buffer_load_dword v80, v67, s[48:51], s77 offen offset:128 sc1
    s_mov_b64 exec, -1
    v_cmp_lt_u32 vcc, 192, v91
    s_mov_b64 exec, vcc
    ds_max_u32 v116, v91 offset:1544
    s_mov_b64 exec, -1
    s_branch K2_X0R
K2_X1:
    v_cmp_lt_u32 vcc, v88, v101
    v_lshrrev_b32 v71, 25, v68
    v_lshlrev_b32 v71, 2, v71
    s_mov_b64 exec, vcc
    ds_add_rtn_u32 v105, v71, v117 offset:0
    s_mov_b64 exec, -1
    v_cmp_lt_u32 vcc, v88, v102
    v_lshrrev_b32 v75, 25, v72
    v_lshlrev_b32 v75, 2, v75
    s_mov_b64 exec, vcc
    ds_add_rtn_u32 v106, v75, v117 offset:0
    s_mov_b64 exec, -1
    v_cmp_lt_u32 vcc, v88, v103
    v_lshrrev_b32 v79, 25, v76
    v_lshlrev_b32 v79, 2, v79
    s_mov_b64 exec, vcc
    ds_add_rtn_u32 v107, v79, v117 offset:0
    s_mov_b64 exec, -1
    v_cmp_lt_u32 vcc, v88, v104
    v_lshrrev_b32 v83, 25, v80
    v_lshlrev_b32 v83, 2, v83
    s_mov_b64 exec, vcc
    ds_add_rtn_u32 v108, v83, v117 offset:0
    s_mov_b64 exec, -1
    s_branch K2_X1R
K2_X2:
    s_mov_b64 exec, -1
    v_cmp_lt_u32 vcc, v88, v101
    s_mov_b64 exec, vcc
    s_cbranch_execz K2_PX0
    ds_read_b32 v20, v71 offset:1024
    s_waitcnt lgkmcnt(0)
    v_add_u32 v20, v20, v105
    ds_write_b32 v20, v68 offset:19264
K2_PX0:
    s_mov_b64 exec, -1
    v_cmp_lt_u32 vcc, v88, v102
    s_mov_b64 exec, vcc
    s_cbranch_execz K2_PX1
    ds_read_b32 v21, v75 offset:1024
    s_waitcnt lgkmcnt(0)
    v_add_u32 v21, v21, v106
    ds_write_b32 v21, v72 offset:19264
K2_PX1:
    s_mov_b64 exec, -1
    v_cmp_lt_u32 vcc, v88, v103
    s_mov_b64 exec, vcc
    s_cbranch_execz K2_PX2
    ds_read_b32 v22, v79 offset:1024
    s_waitcnt lgkmcnt(0)
    v_add_u32 v22, v22, v107
    ds_write_b32 v22, v76 offset:19264
K2_PX2:
    s_mov_b64 exec, -1
    v_cmp_lt_u32 vcc, v88, v104
    s_mov_b64 exec, vcc
    s_cbranch_execz K2_PX3
    ds_read_b32 v23, v83 offset:1024
    s_waitcnt lgkmcnt(0)
    v_add_u32 v23, v23, v108
    ds_write_b32 v23, v80 offset:19264
K2_PX3:
    s_branch K2_X2R
K2_RARE:
    s_mov_b32 s15, 0
    v_cmp_gt_u32 s[74:75], s71, v40
K2_RL0:
    s_cmp_eq_u64 s[74:75], 0
    s_cbranch_scc1 K2_RN0
    s_ff1_i32_b64 s76, s[74:75]
    s_bitset0_b64 s[74:75], s76
    v_readlane_b32 s77, v40, s76
    s_mov_b64 exec, 1
    ds_add_rtn_u32 v17, v116, v117 offset:1556
    s_waitcnt lgkmcnt(0)
    v_readfirstlane_b32 s78, v17
    s_mov_b64 exec, -1
    s_nop 2
    s_cmp_ge_u32 s78, 56
    s_cbranch_scc1 K2_RARED
    s_lshr_b32 s78, s78, 2
    s_add_u32 s78, s78, 1997
    s_mov_b32 m0, s76
    s_nop 0
    v_writelane_b32 v40, s78, m0
    s_lshl_b32 s78, s78, 5
    s_add_u32 m0, s78, 99456
    s_lshl_b32 s77, s77, 5
    s_add_u32 s77, s77, 6400640
    s_mov_b64 exec, 3
    buffer_load_dwordx4 v2, s[48:51], s77 offen lds
    s_mov_b64 exec, -1
    s_branch K2_RL0
K2_RN0:
    v_cmp_gt_u32 s[74:75], s71, v41
K2_RL1:
    s_cmp_eq_u64 s[74:75], 0
    s_cbranch_scc1 K2_RN1
    s_ff1_i32_b64 s76, s[74:75]
    s_bitset0_b64 s[74:75], s76
    v_readlane_b32 s77, v41, s76
    s_mov_b64 exec, 1
    ds_add_rtn_u32 v17, v116, v117 offset:1556
    s_waitcnt lgkmcnt(0)
    v_readfirstlane_b32 s78, v17
    s_mov_b64 exec, -1
    s_nop 2
    s_cmp_ge_u32 s78, 56
    s_cbranch_scc1 K2_RARED
    s_lshr_b32 s78, s78, 2
    s_add_u32 s78, s78, 1997
    s_mov_b32 m0, s76
    s_nop 0
    v_writelane_b32 v41, s78, m0
    s_lshl_b32 s78, s78, 5
    s_add_u32 m0, s78, 99456
    s_lshl_b32 s77, s77, 5
    s_add_u32 s77, s77, 6400640
    s_mov_b64 exec, 3
    buffer_load_dwordx4 v2, s[48:51], s77 offen lds
    s_mov_b64 exec, -1
    s_branch K2_RL1
K2_RN1:
    v_cmp_gt_u32 s[74:75], s71, v42
K2_RL2:
    s_cmp_eq_u64 s[74:75], 0
    s_cbranch_scc1 K2_RN2
    s_ff1_i32_b64 s76, s[74:75]
    s_bitset0_b64 s[74:75], s76
    v_readlane_b32 s77, v42, s76
    s_mov_b64 exec, 1
    ds_add_rtn_u32 v17, v116, v117 offset:1556
    s_waitcnt lgkmcnt(0)
    v_readfirstlane_b32 s78, v17
    s_mov_b64 exec, -1
    s_nop 2
    s_cmp_ge_u32 s78, 56
    s_cbranch_scc1 K2_RARED
    s_lshr_b32 s78, s78, 2
    s_add_u32 s78, s78, 1997
    s_mov_b32 m0, s76
    s_nop 0
    v_writelane_b32 v42, s78, m0
    s_lshl_b32 s78, s78, 5
    s_add_u32 m0, s78, 99456
    s_lshl_b32 s77, s77, 5
    s_add_u32 s77, s77, 6400640
    s_mov_b64 exec, 3
    buffer_load_dwordx4 v2, s[48:51], s77 offen lds
    s_mov_b64 exec, -1
    s_branch K2_RL2
K2_RN2:
    v_cmp_gt_u32 s[74:75], s71, v43
K2_RL3:
    s_cmp_eq_u64 s[74:75], 0
    s_cbranch_scc1 K2_RN3
    s_ff1_i32_b64 s76, s[74:75]
    s_bitset0_b64 s[74:75], s76
    v_readlane_b32 s77, v43, s76
    s_mov_b64 exec, 1
    ds_add_rtn_u32 v17, v116, v117 offset:1556
    s_waitcnt lgkmcnt(0)
    v_readfirstlane_b32 s78, v17
    s_mov_b64 exec, -1
    s_nop 2
    s_cmp_ge_u32 s78, 56
    s_cbranch_scc1 K2_RARED
    s_lshr_b32 s78, s78, 2
    s_add_u32 s78, s78, 1997
    s_mov_b32 m0, s76
    s_nop 0
    v_writelane_b32 v43, s78, m0
    s_lshl_b32 s78, s78, 5
    s_add_u32 m0, s78, 99456
    s_lshl_b32 s77, s77, 5
    s_add_u32 s77, s77, 6400640
    s_mov_b64 exec, 3
    buffer_load_dwordx4 v2, s[48:51], s77 offen lds
    s_mov_b64 exec, -1
    s_branch K2_RL3
K2_RN3:
    s_branch K2_RARED
K2_GALL:
    v_mbcnt_lo_u32_b32 v30, -1, 0
    v_mbcnt_hi_u32_b32 v30, -1, v30
    v_lshlrev_b32 v30, 4, v30
    s_add_u32 s74, s4, 0
    s_lshl_b32 s74, s74, 10
    s_min_u32 s74, s74, 46464
    s_add_u32 m0, s74, 99456
    s_add_u32 s74, s74, 6400640
    buffer_load_dwordx4 v30, s[48:51], s74 offen lds
    s_add_u32 s74, s4, 16
    s_lshl_b32 s74, s74, 10
    s_min_u32 s74, s74, 46464
    s_add_u32 m0, s74, 99456
    s_add_u32 s74, s74, 6400640
    buffer_load_dwordx4 v30, s[48:51], s74 offen lds
    s_add_u32 s74, s4, 32
    s_lshl_b32 s74, s74, 10
    s_min_u32 s74, s74, 46464
    s_add_u32 m0, s74, 99456
    s_add_u32 s74, s74, 6400640
    buffer_load_dwordx4 v30, s[48:51], s74 offen lds
    s_waitcnt vmcnt(0)
    s_barrier
    s_branch K2_GALLD
M_IB_BP:
    s_lshl_b32 s80, s3, 10
    s_sub_u32 s81, 10240000, s80
    s_add_u32 s52, s34, 16777216
    s_addc_u32 s53, s35, 0
    s_add_u32 s52, s52, s80
    s_addc_u32 s53, s53, 0
    s_mov_b32 s54, s81
    s_mov_b32 s55, 0x20000
    s_lshl_b32 s76, s70, 17
    v_lshlrev_b32 v10, 1, v5
    buffer_load_dwordx2 v[6:7], v10, s[52:55], s76 offen sc0 sc1
    buffer_load_dwordx2 v[6:7], v10, s[52:55], s76 offen sc0 sc1
    s_branch M_IB_BD
M_EBS:
    v_mov_b32 v20, v6
    v_mov_b32 v21, v7
    s_branch M_EB
M_EB2_BP:
    s_lshl_b32 s80, s3, 10
    s_sub_u32 s81, 10240000, s80
    s_add_u32 s52, s34, 16777216
    s_addc_u32 s53, s35, 0
    s_add_u32 s52, s52, s80
    s_addc_u32 s53, s53, 0
    s_mov_b32 s54, s81
    s_mov_b32 s55, 0x20000
    s_lshl_b32 s76, s72, 17
    v_lshlrev_b32 v10, 1, v5
    buffer_load_dwordx2 v[6:7], v10, s[52:55], s76 offen sc0 sc1
    s_branch M_EB2_BD
M_EP:
    s_lshl_b32 s80, s3, 10
    s_sub_u32 s81, 10240000, s80
    s_add_u32 s52, s34, 16777216
    s_addc_u32 s53, s35, 0
    s_add_u32 s52, s52, s80
    s_addc_u32 s53, s53, 0
    s_mov_b32 s54, s81
    s_mov_b32 s55, 0x20000
    s_lshl_b32 s76, s76, 1
    v_lshlrev_b32 v13, 1, v5
    v_mov_b32 v30, v20
    v_mov_b32 v31, v21
    buffer_store_dwordx2 v[30:31], v13, s[52:55], s76 offen
    s_branch M_ED
S_IB_BP:
    s_lshl_b32 s80, s3, 10
    s_sub_u32 s81, 10240000, s80
    s_add_u32 s52, s34, 16777216
    s_addc_u32 s53, s35, 0
    s_add_u32 s52, s52, s80
    s_addc_u32 s53, s53, 0
    s_mov_b32 s54, s81
    s_mov_b32 s55, 0x20000
    s_lshl_b32 s76, s70, 17
    v_lshlrev_b32 v10, 1, v5
    buffer_load_dword v6, v10, s[52:55], s76 offen sc0 sc1
    buffer_load_dword v6, v10, s[52:55], s76 offen sc0 sc1
    s_branch S_IB_BD
S_EBS:
    v_mov_b32 v20, v6
    v_mov_b32 v21, v7
    s_branch S_EB
S_EB2_BP:
    s_lshl_b32 s80, s3, 10
    s_sub_u32 s81, 10240000, s80
    s_add_u32 s52, s34, 16777216
    s_addc_u32 s53, s35, 0
    s_add_u32 s52, s52, s80
    s_addc_u32 s53, s53, 0
    s_mov_b32 s54, s81
    s_mov_b32 s55, 0x20000
    s_lshl_b32 s76, s72, 17
    v_lshlrev_b32 v10, 1, v5
    buffer_load_dword v6, v10, s[52:55], s76 offen sc0 sc1
    s_branch S_EB2_BD
S_EP:
    s_lshl_b32 s80, s3, 10
    s_sub_u32 s81, 10240000, s80
    s_add_u32 s52, s34, 16777216
    s_addc_u32 s53, s35, 0
    s_add_u32 s52, s52, s80
    s_addc_u32 s53, s53, 0
    s_mov_b32 s54, s81
    s_mov_b32 s55, 0x20000
    s_lshl_b32 s76, s76, 1
    v_lshlrev_b32 v13, 1, v5
    v_mov_b32 v30, v20
    v_mov_b32 v31, v21
    buffer_store_dword v30, v13, s[52:55], s76 offen
    s_branch S_ED
CODE_END:
.section .rodata,"a"
.p2align 6
.amdhsa_kernel gather_scatter__molecular_angular_painn__graph_kernel
  .amdhsa_next_free_vgpr 128
  .amdhsa_next_free_sgpr 100
  .amdhsa_accum_offset 128
  .amdhsa_group_segment_fixed_size 0
  .amdhsa_kernarg_size 88
  .amdhsa_user_sgpr_count 2
  .amdhsa_user_sgpr_kernarg_segment_ptr 1
  .amdhsa_system_sgpr_workgroup_id_x 1
.end_amdhsa_kernel
```
